```python
import torch

def _softmax(x, axis=-1):
    return torch.softmax(x, dim=axis)

def _gelu(x):
    return torch.nn.functional.gelu(x, approximate='tanh')

def _silu(x):
    return torch.nn.functional.silu(x)

def _sigmoid(x):
    return torch.sigmoid(x)

def _layernorm(x, axis=-1, eps=1e-05):
    m = x.mean(dim=axis, keepdim=True)
    v = x.var(dim=axis, keepdim=True, unbiased=False)
    return (x - m) / torch.sqrt(v + eps)

def _scatter_add(tgt, idx, src, axis=0):
    return tgt.clone().index_add_(axis, idx, src)

def _segment_sum(src, seg, n):
    out = torch.zeros((n,) + src.shape[1:], dtype=src.dtype)
    return out.index_add_(0, seg, src)

def _pad(x, pw):
    flat = tuple((v for pair in reversed(pw) for v in pair))
    return torch.nn.functional.pad(x, flat)
kernel_name = 'standalone__autoregressive_conv_wavernn__speech'

def setup_inputs():

    _w = lambda a: (lambda t: t.to(torch.bfloat16) if t.is_floating_point() else t)(torch.as_tensor(a))
    B, T, D, K = (2, 4000, 512, 3)
    return {'x': _w((lambda *s: torch.randn(*s, dtype=torch.bfloat16) * 0.05)(B, T, D)), 'w': _w((lambda *s: torch.randn(*s, dtype=torch.bfloat16) * 0.05)(K, D, 2 * D))}

def reference(x, w):
    B, T, D = x.shape
    K = w.shape[0]
    dil = 2
    pad = (K - 1) * dil
    xp = _pad(x, ((0, 0), (pad, 0), (0, 0)))
    h = torch.einsum('btd,de->bte', xp[:, 0:T, :], w[0])
    for i in range(1, K):
        h = h + torch.einsum('btd,de->bte', xp[:, i * dil:i * dil + T, :], w[i])
    f, g = (h[..., :D].clone(), h[..., D:].clone())
    return torch.tanh(f) * _sigmoid(g)
```

```asm
; @launch grid=(256,1,1) block=(512,1,1) lds=163840
.amdgcn_target "amdgcn-amd-amdhsa--gfx950"
.text
.globl standalone__autoregressive_conv_wavernn__speech_kernel
.p2align 8
.type standalone__autoregressive_conv_wavernn__speech_kernel,@function
standalone__autoregressive_conv_wavernn__speech_kernel:
s_load_dwordx4 s[4:7], s[0:1], 0
v_readfirstlane_b32 s24, v0
s_cmp_ge_u32 s2, 256
s_cbranch_scc1 L_exit
s_lshr_b32 s3, s2, 5
s_and_b32 s10, s2, 2
s_lshl2_add_u32 s3, s10, s3
s_mul_i32 s26, s3, 256000
s_bitcmp1_b32 s2, 2
s_cselect_b32 s10, 4096000, 0
s_cmp_lt_u32 s24, 256
s_cbranch_scc0 L_consumer
v_bfe_u32 v20, v0, 3, 3
v_and_b32 v21, 7, v0
s_lshr_b32 s3, s24, 4
s_and_b32 s3, s3, 4
s_lshl_b32 s11, s24, 10
s_add_u32 s11, s11, s26
s_lshl_b32 s28, s24, 7
s_addk_i32 s11, -4096
v_xor_b32 v21, s3, v21
v_lshl_add_u32 v20, v20, 6, v21
v_lshl_add_u32 v20, v20, 4, s11
s_mov_b32 s14, 4096000
s_mov_b32 s15, 0x20000
v_min_u32 v8, 0x7ffffff0, v20
s_mov_b32 m0, s28
v_add_u32 v9, 7168, v20
v_xor_b32 v21, 16, v20
v_add_u32 v10, 14336, v21
v_add_u32 v11, 21504, v21
v_xor_b32 v21, 32, v20
v_add_u32 v12, 32768, v21
v_add_u32 v13, 39936, v21
v_xor_b32 v21, 48, v20
v_add_u32 v14, 47104, v21
v_add_u32 v15, 54272, v21
s_mov_b32 s18, 3145728
s_mov_b32 s19, 0x20000
s_and_b32 s3, s2, 1
s_bfe_u32 s11, s2, 0x20003
s_lshl2_add_u32 s3, s3, s11
s_lshl_b32 s27, s3, 7
v_bfe_u32 v20, v0, 4, 3
v_lshlrev_b32 v21, 1, v20
v_xor_b32 v21, v21, v0
v_bfe_u32 v22, v21, 3, 1
v_and_b32 v21, 7, v21
s_lshl_b32 s3, s24, 8
s_add_u32 s3, s3, s27
v_lshl_add_u32 v21, v21, 4, s3
v_lshl_add_u32 v21, v22, 10, v21
v_and_b32 v20, 3, v20
v_lshl_add_u32 v16, v20, 11, v21
s_mul_i32 s29, s24, 384
s_add_u32 s29, s29, 65536
v_add_u32 v17, 7168, v16
s_cmpk_eq_u32 s27, 0x180
s_cbranch_scc0 L_novt0
s_lshr_b32 s3, s2, 5
s_lshl_b32 s3, s3, 13
s_and_b32 s11, s24, 0xc0
s_lshl_b32 s11, s11, 5
s_add_u32 s3, s3, s11
s_add_u32 s3, s3, s27
v_and_b32 v24, 1, v0
v_lshl_add_u32 v24, v24, 10, s3
v_bfe_u32 v25, v0, 1, 2
v_lshl_add_u32 v24, v25, 20, v24
v_bfe_u32 v25, v0, 3, 3
v_lshl_add_u32 v24, v25, 16, v24
s_waitcnt lgkmcnt(0)
s_mov_b32 s16, s6
s_mov_b32 s17, s7
s_bfm_b64 exec, 16, 0
buffer_load_dword v26, v24, s[16:19], 0 offen
s_mov_b64 exec, -1
L_novt0:
s_waitcnt lgkmcnt(0)
s_add_u32 s12, s4, s10
s_addc_u32 s13, s5, 0
buffer_load_dwordx4 v8, s[12:15], 0 offen offset:0  lds
buffer_load_dwordx4 v10, s[12:15], 0 offen offset:2048  lds
s_addk_i32 m0, 4096
s_mov_b32 s16, s6
buffer_load_dwordx4 v12, s[12:15], 0 offen offset:0  lds
buffer_load_dwordx4 v14, s[12:15], 0 offen offset:2048  lds
s_mov_b32 s17, s7
s_mov_b32 m0, s29
s_mov_b32 s30, 0
buffer_load_dwordx4 v16, s[16:19], s30 offen offset:0  lds
buffer_load_dwordx4 v17, s[16:19], s30 offen offset:1024  lds
s_addk_i32 m0, 2048
s_mov_b32 s30, 1048576
buffer_load_dwordx4 v16, s[16:19], s30 offen offset:0  lds
buffer_load_dwordx4 v17, s[16:19], s30 offen offset:1024  lds
s_addk_i32 m0, 2048
s_mov_b32 s30, 2097152
buffer_load_dwordx4 v16, s[16:19], s30 offen offset:0  lds
buffer_load_dwordx4 v17, s[16:19], s30 offen offset:1024  lds
s_mov_b32 m0, s28
s_nop 0
buffer_load_dwordx4 v9, s[12:15], 0 offen offset:1024  lds
buffer_load_dwordx4 v11, s[12:15], 0 offen offset:3072  lds
s_addk_i32 m0, 4096
s_nop 0
buffer_load_dwordx4 v13, s[12:15], 0 offen offset:1024  lds
buffer_load_dwordx4 v15, s[12:15], 0 offen offset:3072  lds
s_add_u32 m0, s29, 6144
s_mov_b32 s30, 65536
buffer_load_dwordx4 v16, s[16:19], s30 offen offset:0  lds
buffer_load_dwordx4 v17, s[16:19], s30 offen offset:1024  lds
s_lshr_b32 s25, s24, 6
s_lshr_b32 s3, s2, 5
s_and_b32 s11, s2, 6
s_lshl2_add_u32 s3, s11, s3
s_lshl2_add_u32 s3, s3, s25
s_lshl_b32 s3, s3, 10
s_add_u32 s97, s3, s27
s_add_u32 s98, s97, 0x100000
s_add_u32 s99, s97, 0x200000
s_mov_b32 s79, 1
s_waitcnt vmcnt(10)
s_barrier
s_buffer_load_dwordx2 s[100:101], s[16:19], s97 offset:131132
s_buffer_load_dwordx2 s[100:101], s[16:19], s98 offset:131132
s_buffer_load_dwordx2 s[100:101], s[16:19], s99 offset:131132
s_addk_i32 m0, 2048
s_mov_b32 s30, 1114112
buffer_load_dwordx4 v16, s[16:19], s30 offen offset:0  lds
buffer_load_dwordx4 v17, s[16:19], s30 offen offset:1024  lds
s_waitcnt vmcnt(10)
s_barrier
s_addk_i32 m0, 2048
s_mov_b32 s30, 2162688
buffer_load_dwordx4 v16, s[16:19], s30 offen offset:0  lds
buffer_load_dwordx4 v17, s[16:19], s30 offen offset:1024  lds
s_waitcnt vmcnt(10)
s_barrier
s_add_u32 m0, s28, 32768
s_movk_i32 s30, 128
buffer_load_dwordx4 v8, s[12:15], s30 offen offset:0  lds
buffer_load_dwordx4 v9, s[12:15], s30 offen offset:1024  lds
buffer_load_dwordx4 v10, s[12:15], s30 offen offset:2048  lds
buffer_load_dwordx4 v11, s[12:15], s30 offen offset:3072  lds
s_waitcnt vmcnt(10)
s_barrier
s_addk_i32 m0, 4096
s_movk_i32 s30, 128
buffer_load_dwordx4 v12, s[12:15], s30 offen offset:0  lds
buffer_load_dwordx4 v13, s[12:15], s30 offen offset:1024  lds
buffer_load_dwordx4 v14, s[12:15], s30 offen offset:2048  lds
buffer_load_dwordx4 v15, s[12:15], s30 offen offset:3072  lds
s_add_u32 m0, s29, 12288
s_mov_b32 s30, 131072
buffer_load_dwordx4 v16, s[16:19], s30 offen offset:0  lds
buffer_load_dwordx4 v17, s[16:19], s30 offen offset:1024  lds
s_waitcnt vmcnt(10)
s_barrier
s_waitcnt lgkmcnt(0)
s_buffer_load_dwordx2 s[100:101], s[16:19], s97 offset:262204
s_buffer_load_dwordx2 s[100:101], s[16:19], s98 offset:262204
s_buffer_load_dwordx2 s[100:101], s[16:19], s99 offset:262204
s_addk_i32 m0, 2048
s_mov_b32 s30, 1179648
buffer_load_dwordx4 v16, s[16:19], s30 offen offset:0  lds
buffer_load_dwordx4 v17, s[16:19], s30 offen offset:1024  lds
s_addk_i32 m0, 2048
s_mov_b32 s30, 2228224
buffer_load_dwordx4 v16, s[16:19], s30 offen offset:0  lds
buffer_load_dwordx4 v17, s[16:19], s30 offen offset:1024  lds
s_addk_i32 m0, 2048
s_mov_b32 s30, 196608
buffer_load_dwordx4 v16, s[16:19], s30 offen offset:0  lds
buffer_load_dwordx4 v17, s[16:19], s30 offen offset:1024  lds
s_addk_i32 m0, 2048
s_mov_b32 s30, 1245184
buffer_load_dwordx4 v16, s[16:19], s30 offen offset:0  lds
buffer_load_dwordx4 v17, s[16:19], s30 offen offset:1024  lds
s_addk_i32 m0, 2048
s_mov_b32 s30, 2293760
buffer_load_dwordx4 v16, s[16:19], s30 offen offset:0  lds
buffer_load_dwordx4 v17, s[16:19], s30 offen offset:1024  lds
s_getpc_b64 s[90:91]
L_pc2:
s_lshr_b32 s3, s2, 3
s_lshl_b32 s3, s3, 2
s_add_u32 s3, s3, s25
s_lshl_b32 s3, s3, 7
s_add_u32 s90, s90, L_consumer-L_pc2+4096
s_addc_u32 s91, s91, 0
s_load_dwordx2 s[100:101], s[90:91], s3 offset:60
s_min_u32 s3, s3, L_end-L_consumer-20480-68
s_load_dwordx2 s[100:101], s[90:91], s3 offset:16444
s_waitcnt vmcnt(6)
s_barrier
s_mov_b32 m0, s28
s_movk_i32 s30, 256
buffer_load_dwordx4 v8, s[12:15], s30 offen offset:0  lds
buffer_load_dwordx4 v9, s[12:15], s30 offen offset:1024  lds
buffer_load_dwordx4 v10, s[12:15], s30 offen offset:2048  lds
buffer_load_dwordx4 v11, s[12:15], s30 offen offset:3072  lds
s_addk_i32 m0, 4096
s_movk_i32 s30, 256
buffer_load_dwordx4 v12, s[12:15], s30 offen offset:0  lds
buffer_load_dwordx4 v13, s[12:15], s30 offen offset:1024  lds
buffer_load_dwordx4 v14, s[12:15], s30 offen offset:2048  lds
buffer_load_dwordx4 v15, s[12:15], s30 offen offset:3072  lds
s_mov_b32 m0, s29
s_mov_b32 s30, 262144
buffer_load_dwordx4 v16, s[16:19], s30 offen offset:0  lds
buffer_load_dwordx4 v17, s[16:19], s30 offen offset:1024  lds
s_branch L_pad1
L_lret1:
s_waitcnt vmcnt(10)
s_barrier
s_waitcnt lgkmcnt(0)
s_buffer_load_dwordx2 s[100:101], s[16:19], s97 offset:393276
s_buffer_load_dwordx2 s[100:101], s[16:19], s98 offset:393276
s_buffer_load_dwordx2 s[100:101], s[16:19], s99 offset:393276
s_addk_i32 m0, 2048
s_mov_b32 s30, 1310720
buffer_load_dwordx4 v16, s[16:19], s30 offen offset:0  lds
buffer_load_dwordx4 v17, s[16:19], s30 offen offset:1024  lds
s_addk_i32 m0, 2048
s_mov_b32 s30, 2359296
buffer_load_dwordx4 v16, s[16:19], s30 offen offset:0  lds
buffer_load_dwordx4 v17, s[16:19], s30 offen offset:1024  lds
s_addk_i32 m0, 2048
s_mov_b32 s30, 327680
buffer_load_dwordx4 v16, s[16:19], s30 offen offset:0  lds
buffer_load_dwordx4 v17, s[16:19], s30 offen offset:1024  lds
s_addk_i32 m0, 2048
s_mov_b32 s30, 1376256
buffer_load_dwordx4 v16, s[16:19], s30 offen offset:0  lds
buffer_load_dwordx4 v17, s[16:19], s30 offen offset:1024  lds
s_addk_i32 m0, 2048
s_mov_b32 s30, 2424832
buffer_load_dwordx4 v16, s[16:19], s30 offen offset:0  lds
buffer_load_dwordx4 v17, s[16:19], s30 offen offset:1024  lds
s_waitcnt vmcnt(6)
s_barrier
s_add_u32 m0, s28, 32768
s_movk_i32 s30, 384
buffer_load_dwordx4 v8, s[12:15], s30 offen offset:0  lds
buffer_load_dwordx4 v9, s[12:15], s30 offen offset:1024  lds
buffer_load_dwordx4 v10, s[12:15], s30 offen offset:2048  lds
buffer_load_dwordx4 v11, s[12:15], s30 offen offset:3072  lds
s_addk_i32 m0, 4096
s_movk_i32 s30, 384
buffer_load_dwordx4 v12, s[12:15], s30 offen offset:0  lds
buffer_load_dwordx4 v13, s[12:15], s30 offen offset:1024  lds
buffer_load_dwordx4 v14, s[12:15], s30 offen offset:2048  lds
buffer_load_dwordx4 v15, s[12:15], s30 offen offset:3072  lds
s_add_u32 m0, s29, 12288
s_mov_b32 s30, 393216
buffer_load_dwordx4 v16, s[16:19], s30 offen offset:0  lds
buffer_load_dwordx4 v17, s[16:19], s30 offen offset:1024  lds
s_waitcnt vmcnt(10)
s_barrier
s_waitcnt lgkmcnt(0)
s_buffer_load_dwordx2 s[100:101], s[16:19], s97 offset:524348
s_buffer_load_dwordx2 s[100:101], s[16:19], s98 offset:524348
s_buffer_load_dwordx2 s[100:101], s[16:19], s99 offset:524348
s_addk_i32 m0, 2048
s_mov_b32 s30, 1441792
buffer_load_dwordx4 v16, s[16:19], s30 offen offset:0  lds
buffer_load_dwordx4 v17, s[16:19], s30 offen offset:1024  lds
s_addk_i32 m0, 2048
s_mov_b32 s30, 2490368
buffer_load_dwordx4 v16, s[16:19], s30 offen offset:0  lds
buffer_load_dwordx4 v17, s[16:19], s30 offen offset:1024  lds
s_addk_i32 m0, 2048
s_mov_b32 s30, 458752
buffer_load_dwordx4 v16, s[16:19], s30 offen offset:0  lds
buffer_load_dwordx4 v17, s[16:19], s30 offen offset:1024  lds
s_addk_i32 m0, 2048
s_mov_b32 s30, 1507328
buffer_load_dwordx4 v16, s[16:19], s30 offen offset:0  lds
buffer_load_dwordx4 v17, s[16:19], s30 offen offset:1024  lds
s_addk_i32 m0, 2048
s_mov_b32 s30, 2555904
buffer_load_dwordx4 v16, s[16:19], s30 offen offset:0  lds
buffer_load_dwordx4 v17, s[16:19], s30 offen offset:1024  lds
s_addk_i32 m0, -22528
s_mov_b32 s30, 524288
buffer_load_dwordx4 v16, s[16:19], s30 offen offset:0  lds
buffer_load_dwordx4 v17, s[16:19], s30 offen offset:1024  lds
s_branch L_pad2
L_lret2:
s_waitcnt vmcnt(8)
s_barrier
s_mov_b32 m0, s28
s_movk_i32 s30, 512
buffer_load_dwordx4 v8, s[12:15], s30 offen offset:0  lds
buffer_load_dwordx4 v9, s[12:15], s30 offen offset:1024  lds
buffer_load_dwordx4 v10, s[12:15], s30 offen offset:2048  lds
buffer_load_dwordx4 v11, s[12:15], s30 offen offset:3072  lds
s_addk_i32 m0, 4096
s_movk_i32 s30, 512
buffer_load_dwordx4 v12, s[12:15], s30 offen offset:0  lds
buffer_load_dwordx4 v13, s[12:15], s30 offen offset:1024  lds
buffer_load_dwordx4 v14, s[12:15], s30 offen offset:2048  lds
buffer_load_dwordx4 v15, s[12:15], s30 offen offset:3072  lds
s_add_u32 m0, s29, 2048
s_mov_b32 s30, 1572864
buffer_load_dwordx4 v16, s[16:19], s30 offen offset:0  lds
buffer_load_dwordx4 v17, s[16:19], s30 offen offset:1024  lds
s_addk_i32 m0, 2048
s_mov_b32 s30, 2621440
buffer_load_dwordx4 v16, s[16:19], s30 offen offset:0  lds
buffer_load_dwordx4 v17, s[16:19], s30 offen offset:1024  lds
s_waitcnt vmcnt(14)
s_barrier
s_waitcnt lgkmcnt(0)
s_buffer_load_dwordx2 s[100:101], s[16:19], s97 offset:655420
s_buffer_load_dwordx2 s[100:101], s[16:19], s98 offset:655420
s_buffer_load_dwordx2 s[100:101], s[16:19], s99 offset:655420
s_addk_i32 m0, 2048
s_mov_b32 s30, 589824
buffer_load_dwordx4 v16, s[16:19], s30 offen offset:0  lds
buffer_load_dwordx4 v17, s[16:19], s30 offen offset:1024  lds
s_addk_i32 m0, 2048
s_mov_b32 s30, 1638400
buffer_load_dwordx4 v16, s[16:19], s30 offen offset:0  lds
buffer_load_dwordx4 v17, s[16:19], s30 offen offset:1024  lds
s_addk_i32 m0, 2048
s_mov_b32 s30, 2686976
buffer_load_dwordx4 v16, s[16:19], s30 offen offset:0  lds
buffer_load_dwordx4 v17, s[16:19], s30 offen offset:1024  lds
s_addk_i32 m0, 2048
s_mov_b32 s30, 655360
buffer_load_dwordx4 v16, s[16:19], s30 offen offset:0  lds
buffer_load_dwordx4 v17, s[16:19], s30 offen offset:1024  lds
s_addk_i32 m0, 2048
s_mov_b32 s30, 1703936
buffer_load_dwordx4 v16, s[16:19], s30 offen offset:0  lds
buffer_load_dwordx4 v17, s[16:19], s30 offen offset:1024  lds
s_addk_i32 m0, 2048
s_mov_b32 s30, 2752512
buffer_load_dwordx4 v16, s[16:19], s30 offen offset:0  lds
buffer_load_dwordx4 v17, s[16:19], s30 offen offset:1024  lds
s_branch L_pad3
L_lret3:
s_waitcnt vmcnt(12)
s_barrier
s_add_u32 m0, s28, 32768
s_movk_i32 s30, 640
buffer_load_dwordx4 v8, s[12:15], s30 offen offset:0  lds
buffer_load_dwordx4 v9, s[12:15], s30 offen offset:1024  lds
buffer_load_dwordx4 v10, s[12:15], s30 offen offset:2048  lds
buffer_load_dwordx4 v11, s[12:15], s30 offen offset:3072  lds
s_addk_i32 m0, 4096
s_movk_i32 s30, 640
buffer_load_dwordx4 v12, s[12:15], s30 offen offset:0  lds
buffer_load_dwordx4 v13, s[12:15], s30 offen offset:1024  lds
buffer_load_dwordx4 v14, s[12:15], s30 offen offset:2048  lds
buffer_load_dwordx4 v15, s[12:15], s30 offen offset:3072  lds
s_add_u32 m0, s29, 18432
s_mov_b32 s30, 720896
buffer_load_dwordx4 v16, s[16:19], s30 offen offset:0  lds
buffer_load_dwordx4 v17, s[16:19], s30 offen offset:1024  lds
s_addk_i32 m0, 2048
s_mov_b32 s30, 1769472
buffer_load_dwordx4 v16, s[16:19], s30 offen offset:0  lds
buffer_load_dwordx4 v17, s[16:19], s30 offen offset:1024  lds
s_waitcnt vmcnt(18)
s_barrier
s_waitcnt lgkmcnt(0)
s_buffer_load_dwordx2 s[100:101], s[16:19], s97 offset:786492
s_buffer_load_dwordx2 s[100:101], s[16:19], s98 offset:786492
s_buffer_load_dwordx2 s[100:101], s[16:19], s99 offset:786492
s_addk_i32 m0, 2048
s_mov_b32 s30, 2818048
buffer_load_dwordx4 v16, s[16:19], s30 offen offset:0  lds
buffer_load_dwordx4 v17, s[16:19], s30 offen offset:1024  lds
s_addk_i32 m0, -22528
s_mov_b32 s30, 786432
buffer_load_dwordx4 v16, s[16:19], s30 offen offset:0  lds
buffer_load_dwordx4 v17, s[16:19], s30 offen offset:1024  lds
s_addk_i32 m0, 2048
s_mov_b32 s30, 1835008
buffer_load_dwordx4 v16, s[16:19], s30 offen offset:0  lds
buffer_load_dwordx4 v17, s[16:19], s30 offen offset:1024  lds
s_addk_i32 m0, 2048
s_mov_b32 s30, 2883584
buffer_load_dwordx4 v16, s[16:19], s30 offen offset:0  lds
buffer_load_dwordx4 v17, s[16:19], s30 offen offset:1024  lds
s_branch L_pad4
L_lret4:
s_branch L_pad5
L_lret5:
s_waitcnt vmcnt(12)
s_barrier
s_mov_b32 m0, s28
s_movk_i32 s30, 768
buffer_load_dwordx4 v8, s[12:15], s30 offen offset:0  lds
buffer_load_dwordx4 v9, s[12:15], s30 offen offset:1024  lds
buffer_load_dwordx4 v10, s[12:15], s30 offen offset:2048  lds
buffer_load_dwordx4 v11, s[12:15], s30 offen offset:3072  lds
s_addk_i32 m0, 4096
s_movk_i32 s30, 768
buffer_load_dwordx4 v12, s[12:15], s30 offen offset:0  lds
buffer_load_dwordx4 v13, s[12:15], s30 offen offset:1024  lds
buffer_load_dwordx4 v14, s[12:15], s30 offen offset:2048  lds
buffer_load_dwordx4 v15, s[12:15], s30 offen offset:3072  lds
s_add_u32 m0, s29, 6144
s_mov_b32 s30, 851968
buffer_load_dwordx4 v16, s[16:19], s30 offen offset:0  lds
buffer_load_dwordx4 v17, s[16:19], s30 offen offset:1024  lds
s_addk_i32 m0, 2048
s_mov_b32 s30, 1900544
buffer_load_dwordx4 v16, s[16:19], s30 offen offset:0  lds
buffer_load_dwordx4 v17, s[16:19], s30 offen offset:1024  lds
s_waitcnt vmcnt(18)
s_barrier
s_waitcnt lgkmcnt(0)
s_buffer_load_dwordx2 s[100:101], s[16:19], s97 offset:917564
s_buffer_load_dwordx2 s[100:101], s[16:19], s98 offset:917564
s_buffer_load_dwordx2 s[100:101], s[16:19], s99 offset:917564
s_addk_i32 m0, 2048
s_mov_b32 s30, 2949120
buffer_load_dwordx4 v16, s[16:19], s30 offen offset:0  lds
buffer_load_dwordx4 v17, s[16:19], s30 offen offset:1024  lds
s_addk_i32 m0, 2048
s_mov_b32 s30, 917504
buffer_load_dwordx4 v16, s[16:19], s30 offen offset:0  lds
buffer_load_dwordx4 v17, s[16:19], s30 offen offset:1024  lds
s_barrier
s_add_u32 m0, s28, 32768
s_movk_i32 s30, 896
buffer_load_dwordx4 v8, s[12:15], s30 offen offset:0  lds
buffer_load_dwordx4 v9, s[12:15], s30 offen offset:1024  lds
buffer_load_dwordx4 v10, s[12:15], s30 offen offset:2048  lds
buffer_load_dwordx4 v11, s[12:15], s30 offen offset:3072  lds
s_addk_i32 m0, 4096
s_movk_i32 s30, 896
buffer_load_dwordx4 v12, s[12:15], s30 offen offset:0  lds
buffer_load_dwordx4 v13, s[12:15], s30 offen offset:1024  lds
buffer_load_dwordx4 v14, s[12:15], s30 offen offset:2048  lds
buffer_load_dwordx4 v15, s[12:15], s30 offen offset:3072  lds
s_waitcnt vmcnt(10)
s_barrier
s_add_u32 m0, s29, 14336
s_mov_b32 s30, 1966080
buffer_load_dwordx4 v16, s[16:19], s30 offen offset:0  lds
buffer_load_dwordx4 v17, s[16:19], s30 offen offset:1024  lds
s_addk_i32 m0, 2048
s_mov_b32 s30, 3014656
buffer_load_dwordx4 v16, s[16:19], s30 offen offset:0  lds
buffer_load_dwordx4 v17, s[16:19], s30 offen offset:1024  lds
s_addk_i32 m0, 2048
s_mov_b32 s30, 983040
buffer_load_dwordx4 v16, s[16:19], s30 offen offset:0  lds
buffer_load_dwordx4 v17, s[16:19], s30 offen offset:1024  lds
s_addk_i32 m0, 2048
s_mov_b32 s30, 2031616
buffer_load_dwordx4 v16, s[16:19], s30 offen offset:0  lds
buffer_load_dwordx4 v17, s[16:19], s30 offen offset:1024  lds
s_addk_i32 m0, 2048
s_mov_b32 s30, 3080192
buffer_load_dwordx4 v16, s[16:19], s30 offen offset:0  lds
buffer_load_dwordx4 v17, s[16:19], s30 offen offset:1024  lds
s_waitcnt vmcnt(6)
s_barrier
s_waitcnt vmcnt(0)
s_barrier
L_exit:
s_endpgm
.p2align 12
L_consumer:
s_load_dwordx2 s[8:9], s[0:1], 16
s_and_b32 s3, s2, 1
s_bfe_u32 s11, s2, 0x20003
s_lshl2_add_u32 s3, s3, s11
s_lshl_b32 s27, s3, 7
v_and_b32 v0, 63, v0
s_bfe_u32 s25, s24, 0x20006
s_lshr_b32 s3, s25, 1
s_and_b32 s11, s25, 1
v_and_b32 v128, 7, v0
v_lshrrev_b32 v129, 2, v0
v_lshrrev_b32 v130, 3, v0
v_xor_b32 v129, v129, v130
v_and_b32 v129, 1, v129
v_lshl_add_u32 v129, v128, 4, v129
s_lshl_b32 s31, s3, 7
v_add_u32 v129, s31, v129
v_lshrrev_b32 v130, 4, v0
v_xor_b32 v131, v130, v128
v_lshlrev_b32 v131, 4, v131
v_lshl_add_u32 v236, v129, 7, v131
v_xor_b32 v238, 64, v236
v_add_u32 v131, 1, v128
v_and_b32 v131, 7, v131
v_xor_b32 v131, v130, v131
v_lshlrev_b32 v131, 4, v131
v_lshl_add_u32 v131, v129, 7, v131
v_add_u32 v237, 2048, v131
v_xor_b32 v239, 64, v237
v_and_b32 v133, 1, v130
v_lshlrev_b32 v133, 5, v133
v_lshl_add_u32 v132, v129, 10, v133
v_lshrrev_b32 v133, 1, v130
v_lshl_add_u32 v132, v133, 4, v132
s_add_u32 s31, s27, s26
s_lshl_b32 s37, s11, 6
s_add_u32 s31, s31, s37
v_add_u32 v244, s31, v132
v_cmp_le_u32 vcc, 240, v129
v_bfrev_b32 v133, 1
v_bfe_u32 v128, v0, 2, 2
v_cndmask_b32 v245, v244, v133, vcc
v_cndmask_b32 v237, v237, v236, vcc
v_cndmask_b32 v239, v239, v238, vcc
v_and_b32 v131, 1, v130
v_lshl_add_u32 v131, v131, 2, v128
s_lshl_b32 s31, s11, 1
v_xor_b32 v131, s31, v131
v_lshlrev_b32 v131, 5, v131
v_lshl_add_u32 v131, v128, 8, v131
v_and_b32 v132, 3, v0
v_lshl_add_u32 v131, v132, 3, v131
v_mul_u32_u24 v132, 24576, v130
v_add_u32 v131, v131, v132
v_add_u32 v240, 65536, v131
v_xor_b32 v241, 32, v240
v_xor_b32 v242, 128, v240
v_xor_b32 v243, 160, v240
s_mov_b32 s34, 0xbfb8aa3b
s_mov_b32 s35, 0xbfb8aa3b
s_mov_b32 s32, 0x4038aa3c
s_mov_b32 s33, 0x4038aa3c
v_mov_b32 v232, 0x40400000
v_mov_b32 v233, 0x40400000
v_mov_b32 v234, 0x40400000
v_mov_b32 v235, 0x40400000
v_mov_b32 v252, 0x408a7fac
v_mov_b32 v253, 0x408a7fac
s_mov_b32 s36, 0x30000000
s_mov_b32 s37, 0x30000000
s_mov_b32 s38, 0xb0800000
s_mov_b32 s39, 0xb0800000
s_mov_b32 s22, 4096000
s_mov_b32 s23, 0x20000
s_movk_i32 s93, 4096
s_movk_i32 s94, 8192
s_movk_i32 s95, 12288
s_waitcnt lgkmcnt(0)
s_add_u32 s20, s8, s10
s_addc_u32 s21, s9, 0
s_mov_b32 s79, 0
s_barrier
ds_read_b64_tr_b16 v[128:129], v240 offset:0
ds_read_b64_tr_b16 v[130:131], v240 offset:1024
ds_read_b128 v[132:135], v236 offset:0
ds_read_b128 v[136:139], v236 offset:256
ds_read_b128 v[140:143], v236 offset:512
ds_read_b128 v[144:147], v236 offset:768
ds_read_b64_tr_b16 v[148:149], v242 offset:0
ds_read_b64_tr_b16 v[150:151], v242 offset:1024
ds_read_b64_tr_b16 v[152:153], v243 offset:0
ds_read_b64_tr_b16 v[154:155], v243 offset:1024
ds_read_b64_tr_b16 v[156:157], v241 offset:0
ds_read_b64_tr_b16 v[158:159], v241 offset:1024
s_waitcnt lgkmcnt(9)
v_mfma_f32_16x16x32_bf16 v[0:3], v[128:131], v[132:135], 0
s_waitcnt lgkmcnt(8)
v_mfma_f32_16x16x32_bf16 v[16:19], v[128:131], v[136:139], 0
s_waitcnt lgkmcnt(7)
v_mfma_f32_16x16x32_bf16 v[32:35], v[128:131], v[140:143], 0
s_waitcnt lgkmcnt(6)
v_mfma_f32_16x16x32_bf16 v[48:51], v[128:131], v[144:147], 0
s_waitcnt lgkmcnt(4)
v_mfma_f32_16x16x32_bf16 v[8:11], v[148:151], v[132:135], v[232:235]
v_mfma_f32_16x16x32_bf16 v[24:27], v[148:151], v[136:139], v[232:235]
v_max_f32 v248, abs(v0), abs(v1)
v_max3_f32 v248, abs(v2), abs(v3), v248
v_mfma_f32_16x16x32_bf16 v[40:43], v[148:151], v[140:143], v[232:235]
v_max3_f32 v248, abs(v16), abs(v17), v248
v_max3_f32 v248, abs(v18), abs(v19), v248
v_mfma_f32_16x16x32_bf16 v[56:59], v[148:151], v[144:147], v[232:235]
s_waitcnt lgkmcnt(2)
s_barrier
ds_read_b64_tr_b16 v[160:161], v242 offset:2048
v_mfma_f32_16x16x32_bf16 v[12:15], v[152:155], v[132:135], v[232:235]
ds_read_b64_tr_b16 v[162:163], v242 offset:3072
v_max3_f32 v248, abs(v32), abs(v33), v248
v_mfma_f32_16x16x32_bf16 v[28:31], v[152:155], v[136:139], v[232:235]
ds_read_b128 v[164:167], v237 offset:0
v_max3_f32 v248, abs(v34), abs(v35), v248
v_mfma_f32_16x16x32_bf16 v[44:47], v[152:155], v[140:143], v[232:235]
ds_read_b64_tr_b16 v[168:169], v243 offset:2048
v_max3_f32 v248, abs(v48), abs(v49), v248
v_mfma_f32_16x16x32_bf16 v[60:63], v[152:155], v[144:147], v[232:235]
s_waitcnt lgkmcnt(4)
ds_read_b64_tr_b16 v[170:171], v243 offset:3072
v_max3_f32 v248, abs(v50), abs(v51), v248
v_and_b32 v248, 0x7f800000, v248
v_min_u32 v248, 0x3c800000, v248
v_add_u32 v248, 0x2400000, v248
v_mov_b32 v249, v248
v_mov_b32 v250, v248
v_mov_b32 v251, v248
s_nop 0
s_nop 0
v_mfma_f32_16x16x32_bf16 v[4:7], v[156:159], v[132:135], v[248:251]
ds_read_b64_tr_b16 v[172:173], v241 offset:2048
v_add_f32 v0, v0, v248
v_mfma_f32_16x16x32_bf16 v[20:23], v[156:159], v[136:139], v[248:251]
ds_read_b64_tr_b16 v[174:175], v241 offset:3072
v_add_f32 v1, v1, v248
v_mfma_f32_16x16x32_bf16 v[36:39], v[156:159], v[140:143], v[248:251]
ds_read_b64_tr_b16 v[176:177], v240 offset:2048
v_add_f32 v2, v2, v248
v_mfma_f32_16x16x32_bf16 v[52:55], v[156:159], v[144:147], v[248:251]
s_waitcnt lgkmcnt(6)
ds_read_b64_tr_b16 v[178:179], v240 offset:3072
v_add_f32 v3, v3, v248
v_mfma_f32_16x16x32_bf16 v[8:11], v[160:163], v[136:139], v[8:11]
v_add_f32 v16, v16, v248
v_add_f32 v17, v17, v248
v_mfma_f32_16x16x32_bf16 v[24:27], v[160:163], v[140:143], v[24:27]
v_add_f32 v18, v18, v248
v_add_f32 v19, v19, v248
v_mfma_f32_16x16x32_bf16 v[40:43], v[160:163], v[144:147], v[40:43]
s_waitcnt lgkmcnt(6)
v_add_f32 v32, v32, v248
v_add_f32 v33, v33, v248
v_mfma_f32_16x16x32_bf16 v[120:123], v[160:163], v[164:167], v[232:235]
s_waitcnt lgkmcnt(4)
v_add_f32 v34, v34, v248
v_add_f32 v35, v35, v248
v_mfma_f32_16x16x32_bf16 v[12:15], v[168:171], v[136:139], v[12:15]
v_add_f32 v48, v48, v248
v_add_f32 v49, v49, v248
v_mfma_f32_16x16x32_bf16 v[28:31], v[168:171], v[140:143], v[28:31]
v_add_f32 v50, v50, v248
v_add_f32 v51, v51, v248
v_mfma_f32_16x16x32_bf16 v[44:47], v[168:171], v[144:147], v[44:47]
v_mul_f32 v246, 0xc038aa3c, v248
v_mul_f32 v247, 0xc038aa3c, v248
v_mfma_f32_16x16x32_bf16 v[124:127], v[168:171], v[164:167], v[232:235]
s_waitcnt lgkmcnt(2)
s_barrier
ds_read_b64_tr_b16 v[180:181], v242 offset:4096
v_mfma_f32_16x16x32_bf16 v[4:7], v[172:175], v[136:139], v[4:7]
ds_read_b64_tr_b16 v[182:183], v242 offset:5120
v_mfma_f32_16x16x32_bf16 v[20:23], v[172:175], v[140:143], v[20:23]
ds_read_b128 v[184:187], v237 offset:256
v_mfma_f32_16x16x32_bf16 v[36:39], v[172:175], v[144:147], v[36:39]
ds_read_b64_tr_b16 v[188:189], v243 offset:4096
v_mfma_f32_16x16x32_bf16 v[116:119], v[172:175], v[164:167], v[248:251]
s_waitcnt lgkmcnt(4)
ds_read_b64_tr_b16 v[190:191], v243 offset:5120
v_mfma_f32_16x16x32_bf16 v[0:3], v[176:179], v[136:139], v[0:3]
ds_read_b64_tr_b16 v[192:193], v241 offset:4096
v_mfma_f32_16x16x32_bf16 v[16:19], v[176:179], v[140:143], v[16:19]
ds_read_b64_tr_b16 v[194:195], v241 offset:5120
v_mfma_f32_16x16x32_bf16 v[32:35], v[176:179], v[144:147], v[32:35]
ds_read_b64_tr_b16 v[196:197], v240 offset:4096
v_mfma_f32_16x16x32_bf16 v[112:115], v[176:179], v[164:167], v[248:251]
s_waitcnt lgkmcnt(6)
ds_read_b64_tr_b16 v[198:199], v240 offset:5120
v_mfma_f32_16x16x32_bf16 v[8:11], v[180:183], v[140:143], v[8:11]
v_mfma_f32_16x16x32_bf16 v[24:27], v[180:183], v[144:147], v[24:27]
v_mfma_f32_16x16x32_bf16 v[104:107], v[180:183], v[164:167], v[232:235]
s_waitcnt lgkmcnt(6)
v_mfma_f32_16x16x32_bf16 v[120:123], v[180:183], v[184:187], v[120:123]
s_waitcnt lgkmcnt(4)
v_mfma_f32_16x16x32_bf16 v[12:15], v[188:191], v[140:143], v[12:15]
v_mfma_f32_16x16x32_bf16 v[28:31], v[188:191], v[144:147], v[28:31]
v_mfma_f32_16x16x32_bf16 v[108:111], v[188:191], v[164:167], v[232:235]
v_mfma_f32_16x16x32_bf16 v[124:127], v[188:191], v[184:187], v[124:127]
s_waitcnt lgkmcnt(2)
s_barrier
ds_read_b128 v[200:203], v236 offset:1024
v_mfma_f32_16x16x32_bf16 v[4:7], v[192:195], v[140:143], v[4:7]
ds_read_b128 v[204:207], v236 offset:1280
v_mfma_f32_16x16x32_bf16 v[20:23], v[192:195], v[144:147], v[20:23]
ds_read_b128 v[208:211], v236 offset:1536
v_mfma_f32_16x16x32_bf16 v[100:103], v[192:195], v[164:167], v[248:251]
ds_read_b128 v[212:215], v236 offset:1792
v_mfma_f32_16x16x32_bf16 v[116:119], v[192:195], v[184:187], v[116:119]
s_waitcnt lgkmcnt(4)
v_mfma_f32_16x16x32_bf16 v[0:3], v[196:199], v[140:143], v[0:3]
v_mfma_f32_16x16x32_bf16 v[16:19], v[196:199], v[144:147], v[16:19]
v_mfma_f32_16x16x32_bf16 v[96:99], v[196:199], v[164:167], v[248:251]
v_mfma_f32_16x16x32_bf16 v[112:115], v[196:199], v[184:187], v[112:115]
s_waitcnt lgkmcnt(3)
v_mfma_f32_16x16x32_bf16 v[32:35], v[196:199], v[200:203], v[32:35]
s_waitcnt lgkmcnt(2)
v_mfma_f32_16x16x32_bf16 v[48:51], v[196:199], v[204:207], v[48:51]
v_mfma_f32_16x16x32_bf16 v[48:51], v[176:179], v[200:203], v[48:51]
v_mfma_f32_16x16x32_bf16 v[64:67], v[128:131], v[200:203], v[248:251]
v_mfma_f32_16x16x32_bf16 v[64:67], v[176:179], v[204:207], v[64:67]
s_waitcnt lgkmcnt(1)
v_mfma_f32_16x16x32_bf16 v[64:67], v[196:199], v[208:211], v[64:67]
s_waitcnt lgkmcnt(0)
v_mfma_f32_16x16x32_bf16 v[80:83], v[196:199], v[212:215], v[248:251]
v_mfma_f32_16x16x32_bf16 v[80:83], v[176:179], v[208:211], v[80:83]
v_mfma_f32_16x16x32_bf16 v[80:83], v[128:131], v[204:207], v[80:83]
v_mfma_f32_16x16x32_bf16 v[96:99], v[128:131], v[208:211], v[96:99]
v_mfma_f32_16x16x32_bf16 v[96:99], v[176:179], v[212:215], v[96:99]
v_mfma_f32_16x16x32_bf16 v[112:115], v[128:131], v[212:215], v[112:115]
v_mfma_f32_16x16x32_bf16 v[40:43], v[180:183], v[200:203], v[40:43]
v_mfma_f32_16x16x32_bf16 v[56:59], v[180:183], v[204:207], v[56:59]
v_mfma_f32_16x16x32_bf16 v[56:59], v[160:163], v[200:203], v[56:59]
v_mfma_f32_16x16x32_bf16 v[72:75], v[148:151], v[200:203], v[232:235]
v_mfma_f32_16x16x32_bf16 v[72:75], v[160:163], v[204:207], v[72:75]
v_mfma_f32_16x16x32_bf16 v[72:75], v[180:183], v[208:211], v[72:75]
v_mfma_f32_16x16x32_bf16 v[88:91], v[180:183], v[212:215], v[232:235]
v_mfma_f32_16x16x32_bf16 v[88:91], v[160:163], v[208:211], v[88:91]
v_mfma_f32_16x16x32_bf16 v[88:91], v[148:151], v[204:207], v[88:91]
v_mfma_f32_16x16x32_bf16 v[104:107], v[148:151], v[208:211], v[104:107]
v_mfma_f32_16x16x32_bf16 v[104:107], v[160:163], v[212:215], v[104:107]
v_mfma_f32_16x16x32_bf16 v[120:123], v[148:151], v[212:215], v[120:123]
v_mfma_f32_16x16x32_bf16 v[36:39], v[192:195], v[200:203], v[36:39]
v_mfma_f32_16x16x32_bf16 v[52:55], v[192:195], v[204:207], v[52:55]
v_mfma_f32_16x16x32_bf16 v[52:55], v[172:175], v[200:203], v[52:55]
v_mfma_f32_16x16x32_bf16 v[68:71], v[156:159], v[200:203], v[248:251]
v_mfma_f32_16x16x32_bf16 v[68:71], v[172:175], v[204:207], v[68:71]
v_mfma_f32_16x16x32_bf16 v[68:71], v[192:195], v[208:211], v[68:71]
v_mfma_f32_16x16x32_bf16 v[84:87], v[192:195], v[212:215], v[248:251]
v_mfma_f32_16x16x32_bf16 v[84:87], v[172:175], v[208:211], v[84:87]
v_mfma_f32_16x16x32_bf16 v[84:87], v[156:159], v[204:207], v[84:87]
v_mfma_f32_16x16x32_bf16 v[100:103], v[156:159], v[208:211], v[100:103]
v_mfma_f32_16x16x32_bf16 v[100:103], v[172:175], v[212:215], v[100:103]
s_barrier
ds_read_b64_tr_b16 v[216:217], v240 offset:6144
v_mfma_f32_16x16x32_bf16 v[116:119], v[156:159], v[212:215], v[116:119]
ds_read_b64_tr_b16 v[218:219], v240 offset:7168
v_mfma_f32_16x16x32_bf16 v[44:47], v[188:191], v[200:203], v[44:47]
ds_read_b128 v[220:223], v238 offset:0
v_mfma_f32_16x16x32_bf16 v[60:63], v[188:191], v[204:207], v[60:63]
ds_read_b64_tr_b16 v[224:225], v240 offset:8192
v_mfma_f32_16x16x32_bf16 v[60:63], v[168:171], v[200:203], v[60:63]
ds_read_b64_tr_b16 v[226:227], v240 offset:9216
v_mfma_f32_16x16x32_bf16 v[76:79], v[152:155], v[200:203], v[232:235]
ds_read_b128 v[228:231], v238 offset:256
v_mfma_f32_16x16x32_bf16 v[76:79], v[168:171], v[204:207], v[76:79]
ds_read_b64_tr_b16 v[132:133], v240 offset:10240
v_mfma_f32_16x16x32_bf16 v[76:79], v[188:191], v[208:211], v[76:79]
ds_read_b64_tr_b16 v[134:135], v240 offset:11264
v_mfma_f32_16x16x32_bf16 v[92:95], v[188:191], v[212:215], v[232:235]
ds_read_b128 v[136:139], v238 offset:512
v_mfma_f32_16x16x32_bf16 v[92:95], v[168:171], v[208:211], v[92:95]
ds_read_b128 v[140:143], v238 offset:768
v_mfma_f32_16x16x32_bf16 v[92:95], v[152:155], v[204:207], v[92:95]
ds_read_b128 v[144:147], v238 offset:1024
v_mfma_f32_16x16x32_bf16 v[108:111], v[152:155], v[208:211], v[108:111]
ds_read_b128 v[164:167], v238 offset:1280
v_mfma_f32_16x16x32_bf16 v[108:111], v[168:171], v[212:215], v[108:111]
ds_read_b128 v[184:187], v238 offset:1536
v_mfma_f32_16x16x32_bf16 v[124:127], v[152:155], v[212:215], v[124:127]
s_waitcnt lgkmcnt(10)
ds_read_b128 v[196:199], v238 offset:1792
v_mfma_f32_16x16x32_bf16 v[0:3], v[216:219], v[220:223], v[0:3]
s_waitcnt lgkmcnt(8)
ds_read_b128 v[176:179], v239 offset:0
v_mfma_f32_16x16x32_bf16 v[0:3], v[224:227], v[228:231], v[0:3]
s_waitcnt lgkmcnt(6)
ds_read_b128 v[128:131], v239 offset:256
v_mfma_f32_16x16x32_bf16 v[0:3], v[132:135], v[136:139], v[0:3]
s_waitcnt lgkmcnt(6)
ds_read_b64_tr_b16 v[180:181], v242 offset:6144
v_mfma_f32_16x16x32_bf16 v[16:19], v[132:135], v[140:143], v[16:19]
ds_read_b64_tr_b16 v[182:183], v242 offset:7168
v_mfma_f32_16x16x32_bf16 v[16:19], v[224:227], v[136:139], v[16:19]
ds_read_b64_tr_b16 v[160:161], v242 offset:8192
v_mfma_f32_16x16x32_bf16 v[16:19], v[216:219], v[228:231], v[16:19]
ds_read_b64_tr_b16 v[162:163], v242 offset:9216
v_mfma_f32_16x16x32_bf16 v[32:35], v[216:219], v[136:139], v[32:35]
ds_read_b64_tr_b16 v[148:149], v242 offset:10240
v_mfma_f32_16x16x32_bf16 v[32:35], v[224:227], v[140:143], v[32:35]
s_waitcnt lgkmcnt(10)
ds_read_b64_tr_b16 v[150:151], v242 offset:11264
v_mfma_f32_16x16x32_bf16 v[32:35], v[132:135], v[144:147], v[32:35]
s_waitcnt lgkmcnt(10)
ds_read_b64_tr_b16 v[192:193], v241 offset:6144
v_mfma_f32_16x16x32_bf16 v[48:51], v[132:135], v[164:167], v[48:51]
ds_read_b64_tr_b16 v[194:195], v241 offset:7168
v_mfma_f32_16x16x32_bf16 v[48:51], v[224:227], v[144:147], v[48:51]
ds_read_b64_tr_b16 v[172:173], v241 offset:8192
v_mfma_f32_16x16x32_bf16 v[48:51], v[216:219], v[140:143], v[48:51]
ds_read_b64_tr_b16 v[174:175], v241 offset:9216
v_mfma_f32_16x16x32_bf16 v[64:67], v[216:219], v[144:147], v[64:67]
ds_read_b64_tr_b16 v[156:157], v241 offset:10240
v_mfma_f32_16x16x32_bf16 v[64:67], v[224:227], v[164:167], v[64:67]
s_waitcnt lgkmcnt(14)
ds_read_b64_tr_b16 v[158:159], v241 offset:11264
v_mfma_f32_16x16x32_bf16 v[64:67], v[132:135], v[184:187], v[64:67]
s_waitcnt lgkmcnt(14)
v_mfma_f32_16x16x32_bf16 v[80:83], v[132:135], v[196:199], v[80:83]
v_mfma_f32_16x16x32_bf16 v[80:83], v[224:227], v[184:187], v[80:83]
v_mfma_f32_16x16x32_bf16 v[80:83], v[216:219], v[164:167], v[80:83]
v_mfma_f32_16x16x32_bf16 v[96:99], v[216:219], v[184:187], v[96:99]
v_mfma_f32_16x16x32_bf16 v[96:99], v[224:227], v[196:199], v[96:99]
s_waitcnt lgkmcnt(13)
v_mfma_f32_16x16x32_bf16 v[96:99], v[132:135], v[176:179], v[96:99]
s_waitcnt lgkmcnt(12)
v_mfma_f32_16x16x32_bf16 v[112:115], v[132:135], v[128:131], v[112:115]
v_mfma_f32_16x16x32_bf16 v[112:115], v[224:227], v[176:179], v[112:115]
v_mfma_f32_16x16x32_bf16 v[112:115], v[216:219], v[196:199], v[112:115]
s_waitcnt lgkmcnt(10)
v_mfma_f32_16x16x32_bf16 v[120:123], v[180:183], v[196:199], v[120:123]
s_waitcnt lgkmcnt(8)
ds_read_b64_tr_b16 v[200:201], v243 offset:6144
v_mfma_f32_16x16x32_bf16 v[120:123], v[160:163], v[176:179], v[120:123]
s_waitcnt lgkmcnt(7)
ds_read_b64_tr_b16 v[202:203], v243 offset:7168
v_mfma_f32_16x16x32_bf16 v[120:123], v[148:151], v[128:131], v[120:123]
ds_read_b64_tr_b16 v[188:189], v243 offset:8192
v_mfma_f32_16x16x32_bf16 v[104:107], v[148:151], v[176:179], v[104:107]
ds_read_b64_tr_b16 v[190:191], v243 offset:9216
v_mfma_f32_16x16x32_bf16 v[104:107], v[160:163], v[196:199], v[104:107]
ds_read_b64_tr_b16 v[204:205], v243 offset:10240
v_mfma_f32_16x16x32_bf16 v[104:107], v[180:183], v[184:187], v[104:107]
ds_read_b64_tr_b16 v[206:207], v243 offset:11264
v_mfma_f32_16x16x32_bf16 v[88:91], v[180:183], v[164:167], v[88:91]
v_mfma_f32_16x16x32_bf16 v[88:91], v[160:163], v[184:187], v[88:91]
v_mfma_f32_16x16x32_bf16 v[88:91], v[148:151], v[196:199], v[88:91]
v_mfma_f32_16x16x32_bf16 v[72:75], v[148:151], v[184:187], v[72:75]
v_mfma_f32_16x16x32_bf16 v[72:75], v[160:163], v[164:167], v[72:75]
v_mfma_f32_16x16x32_bf16 v[72:75], v[180:183], v[144:147], v[72:75]
v_mfma_f32_16x16x32_bf16 v[56:59], v[180:183], v[140:143], v[56:59]
v_mfma_f32_16x16x32_bf16 v[56:59], v[160:163], v[144:147], v[56:59]
v_mfma_f32_16x16x32_bf16 v[56:59], v[148:151], v[164:167], v[56:59]
v_mfma_f32_16x16x32_bf16 v[40:43], v[148:151], v[144:147], v[40:43]
v_mfma_f32_16x16x32_bf16 v[40:43], v[160:163], v[140:143], v[40:43]
v_mfma_f32_16x16x32_bf16 v[40:43], v[180:183], v[136:139], v[40:43]
v_mfma_f32_16x16x32_bf16 v[24:27], v[180:183], v[228:231], v[24:27]
v_mfma_f32_16x16x32_bf16 v[24:27], v[160:163], v[136:139], v[24:27]
v_mfma_f32_16x16x32_bf16 v[24:27], v[148:151], v[140:143], v[24:27]
v_mfma_f32_16x16x32_bf16 v[8:11], v[148:151], v[136:139], v[8:11]
v_mfma_f32_16x16x32_bf16 v[8:11], v[160:163], v[228:231], v[8:11]
v_mfma_f32_16x16x32_bf16 v[8:11], v[180:183], v[220:223], v[8:11]
s_waitcnt lgkmcnt(10)
v_mfma_f32_16x16x32_bf16 v[4:7], v[192:195], v[220:223], v[4:7]
s_waitcnt lgkmcnt(8)
v_mfma_f32_16x16x32_bf16 v[4:7], v[172:175], v[228:231], v[4:7]
s_waitcnt lgkmcnt(6)
v_mfma_f32_16x16x32_bf16 v[4:7], v[156:159], v[136:139], v[4:7]
v_mfma_f32_16x16x32_bf16 v[20:23], v[156:159], v[140:143], v[20:23]
v_mfma_f32_16x16x32_bf16 v[20:23], v[172:175], v[136:139], v[20:23]
v_mfma_f32_16x16x32_bf16 v[20:23], v[192:195], v[228:231], v[20:23]
v_mfma_f32_16x16x32_bf16 v[36:39], v[192:195], v[136:139], v[36:39]
v_mfma_f32_16x16x32_bf16 v[36:39], v[172:175], v[140:143], v[36:39]
v_mfma_f32_16x16x32_bf16 v[36:39], v[156:159], v[144:147], v[36:39]
v_mfma_f32_16x16x32_bf16 v[52:55], v[156:159], v[164:167], v[52:55]
v_mfma_f32_16x16x32_bf16 v[52:55], v[172:175], v[144:147], v[52:55]
v_mfma_f32_16x16x32_bf16 v[52:55], v[192:195], v[140:143], v[52:55]
v_mfma_f32_16x16x32_bf16 v[68:71], v[192:195], v[144:147], v[68:71]
v_mfma_f32_16x16x32_bf16 v[68:71], v[172:175], v[164:167], v[68:71]
v_mfma_f32_16x16x32_bf16 v[68:71], v[156:159], v[184:187], v[68:71]
v_mfma_f32_16x16x32_bf16 v[84:87], v[156:159], v[196:199], v[84:87]
v_mfma_f32_16x16x32_bf16 v[84:87], v[172:175], v[184:187], v[84:87]
v_mfma_f32_16x16x32_bf16 v[84:87], v[192:195], v[164:167], v[84:87]
v_mfma_f32_16x16x32_bf16 v[100:103], v[192:195], v[184:187], v[100:103]
v_mfma_f32_16x16x32_bf16 v[100:103], v[172:175], v[196:199], v[100:103]
v_mfma_f32_16x16x32_bf16 v[100:103], v[156:159], v[176:179], v[100:103]
v_mfma_f32_16x16x32_bf16 v[116:119], v[156:159], v[128:131], v[116:119]
v_mfma_f32_16x16x32_bf16 v[116:119], v[172:175], v[176:179], v[116:119]
v_mfma_f32_16x16x32_bf16 v[116:119], v[192:195], v[196:199], v[116:119]
s_waitcnt lgkmcnt(4)
s_barrier
ds_read_b64_tr_b16 v[208:209], v240 offset:12288
v_mfma_f32_16x16x32_bf16 v[124:127], v[200:203], v[196:199], v[124:127]
s_waitcnt lgkmcnt(3)
ds_read_b64_tr_b16 v[210:211], v240 offset:13312
v_mfma_f32_16x16x32_bf16 v[124:127], v[188:191], v[176:179], v[124:127]
s_waitcnt lgkmcnt(2)
ds_read_b128 v[168:171], v236 offset:32768
v_mfma_f32_16x16x32_bf16 v[124:127], v[204:207], v[128:131], v[124:127]
ds_read_b64_tr_b16 v[152:153], v240 offset:14336
v_mfma_f32_16x16x32_bf16 v[108:111], v[204:207], v[176:179], v[108:111]
ds_read_b64_tr_b16 v[154:155], v240 offset:15360
v_mfma_f32_16x16x32_bf16 v[108:111], v[188:191], v[196:199], v[108:111]
ds_read_b128 v[212:215], v236 offset:33024
v_mfma_f32_16x16x32_bf16 v[108:111], v[200:203], v[184:187], v[108:111]
ds_read_b64_tr_b16 v[232:233], v240 offset:16384
v_mfma_f32_16x16x32_bf16 v[92:95], v[200:203], v[164:167], v[92:95]
ds_read_b64_tr_b16 v[234:235], v240 offset:17408
v_mfma_f32_16x16x32_bf16 v[92:95], v[188:191], v[184:187], v[92:95]
ds_read_b128 v[248:251], v236 offset:33280
v_mfma_f32_16x16x32_bf16 v[92:95], v[204:207], v[196:199], v[92:95]
ds_read_b128 v[132:135], v236 offset:33536
v_mfma_f32_16x16x32_bf16 v[76:79], v[204:207], v[184:187], v[76:79]
ds_read_b128 v[224:227], v236 offset:33792
v_mfma_f32_16x16x32_bf16 v[76:79], v[188:191], v[164:167], v[76:79]
ds_read_b128 v[216:219], v236 offset:34048
v_mfma_f32_16x16x32_bf16 v[76:79], v[200:203], v[144:147], v[76:79]
ds_read_b128 v[148:151], v236 offset:34304
v_mfma_f32_16x16x32_bf16 v[60:63], v[200:203], v[140:143], v[60:63]
ds_read_b128 v[160:163], v236 offset:34560
v_mfma_f32_16x16x32_bf16 v[60:63], v[188:191], v[144:147], v[60:63]
ds_read_b128 v[180:183], v237 offset:32768
v_mfma_f32_16x16x32_bf16 v[60:63], v[204:207], v[164:167], v[60:63]
ds_read_b128 v[156:159], v237 offset:33024
v_mfma_f32_16x16x32_bf16 v[44:47], v[204:207], v[144:147], v[44:47]
ds_read_b64_tr_b16 v[172:173], v242 offset:12288
v_mfma_f32_16x16x32_bf16 v[44:47], v[188:191], v[140:143], v[44:47]
ds_read_b64_tr_b16 v[174:175], v242 offset:13312
v_mfma_f32_16x16x32_bf16 v[44:47], v[200:203], v[136:139], v[44:47]
ds_read_b64_tr_b16 v[192:193], v242 offset:14336
v_mfma_f32_16x16x32_bf16 v[28:31], v[200:203], v[228:231], v[28:31]
ds_read_b64_tr_b16 v[194:195], v242 offset:15360
v_mfma_f32_16x16x32_bf16 v[28:31], v[188:191], v[136:139], v[28:31]
ds_read_b64_tr_b16 v[128:129], v242 offset:16384
v_mfma_f32_16x16x32_bf16 v[28:31], v[204:207], v[140:143], v[28:31]
ds_read_b64_tr_b16 v[130:131], v242 offset:17408
v_mfma_f32_16x16x32_bf16 v[12:15], v[204:207], v[136:139], v[12:15]
v_mfma_f32_16x16x32_bf16 v[12:15], v[188:191], v[228:231], v[12:15]
v_mfma_f32_16x16x32_bf16 v[12:15], v[200:203], v[220:223], v[12:15]
s_waitcnt lgkmcnt(14)
v_mfma_f32_16x16x32_bf16 v[0:3], v[208:211], v[168:171], v[0:3]
ds_read_b64_tr_b16 v[176:177], v241 offset:12288
v_mfma_f32_16x16x32_bf16 v[0:3], v[152:155], v[212:215], v[0:3]
s_waitcnt lgkmcnt(14)
ds_read_b64_tr_b16 v[178:179], v241 offset:13312
v_mfma_f32_16x16x32_bf16 v[0:3], v[232:235], v[248:251], v[0:3]
s_waitcnt lgkmcnt(14)
ds_read_b64_tr_b16 v[196:197], v241 offset:14336
v_mfma_f32_16x16x32_bf16 v[16:19], v[232:235], v[132:135], v[16:19]
ds_read_b64_tr_b16 v[198:199], v241 offset:15360
v_mfma_f32_16x16x32_bf16 v[16:19], v[152:155], v[248:251], v[16:19]
ds_read_b64_tr_b16 v[184:185], v241 offset:16384
v_mfma_f32_16x16x32_bf16 v[16:19], v[208:211], v[212:215], v[16:19]
ds_read_b64_tr_b16 v[186:187], v241 offset:17408
v_mfma_f32_16x16x32_bf16 v[32:35], v[208:211], v[248:251], v[32:35]
v_mfma_f32_16x16x32_bf16 v[32:35], v[152:155], v[132:135], v[32:35]
s_waitcnt lgkmcnt(14)
v_mfma_f32_16x16x32_bf16 v[32:35], v[232:235], v[224:227], v[32:35]
v_mfma_f32_16x16x32_bf16 v[48:51], v[232:235], v[216:219], v[48:51]
v_mfma_f32_16x16x32_bf16 v[48:51], v[152:155], v[224:227], v[48:51]
v_mfma_f32_16x16x32_bf16 v[48:51], v[208:211], v[132:135], v[48:51]
v_mfma_f32_16x16x32_bf16 v[64:67], v[208:211], v[224:227], v[64:67]
v_mfma_f32_16x16x32_bf16 v[64:67], v[152:155], v[216:219], v[64:67]
v_mfma_f32_16x16x32_bf16 v[64:67], v[232:235], v[148:151], v[64:67]
v_mfma_f32_16x16x32_bf16 v[80:83], v[232:235], v[160:163], v[80:83]
v_mfma_f32_16x16x32_bf16 v[80:83], v[152:155], v[148:151], v[80:83]
v_mfma_f32_16x16x32_bf16 v[80:83], v[208:211], v[216:219], v[80:83]
v_mfma_f32_16x16x32_bf16 v[96:99], v[208:211], v[148:151], v[96:99]
v_mfma_f32_16x16x32_bf16 v[96:99], v[152:155], v[160:163], v[96:99]
s_waitcnt lgkmcnt(13)
v_mfma_f32_16x16x32_bf16 v[96:99], v[232:235], v[180:183], v[96:99]
s_waitcnt lgkmcnt(12)
v_mfma_f32_16x16x32_bf16 v[112:115], v[232:235], v[156:159], v[112:115]
v_mfma_f32_16x16x32_bf16 v[112:115], v[152:155], v[180:183], v[112:115]
v_mfma_f32_16x16x32_bf16 v[112:115], v[208:211], v[160:163], v[112:115]
s_waitcnt lgkmcnt(10)
v_mfma_f32_16x16x32_bf16 v[120:123], v[172:175], v[160:163], v[120:123]
s_waitcnt lgkmcnt(8)
ds_read_b64_tr_b16 v[164:165], v243 offset:12288
v_mfma_f32_16x16x32_bf16 v[120:123], v[192:195], v[180:183], v[120:123]
s_waitcnt lgkmcnt(7)
ds_read_b64_tr_b16 v[166:167], v243 offset:13312
v_mfma_f32_16x16x32_bf16 v[120:123], v[128:131], v[156:159], v[120:123]
ds_read_b64_tr_b16 v[144:145], v243 offset:14336
v_mfma_f32_16x16x32_bf16 v[104:107], v[128:131], v[180:183], v[104:107]
ds_read_b64_tr_b16 v[146:147], v243 offset:15360
v_mfma_f32_16x16x32_bf16 v[104:107], v[192:195], v[160:163], v[104:107]
ds_read_b64_tr_b16 v[140:141], v243 offset:16384
v_mfma_f32_16x16x32_bf16 v[104:107], v[172:175], v[148:151], v[104:107]
ds_read_b64_tr_b16 v[142:143], v243 offset:17408
v_mfma_f32_16x16x32_bf16 v[88:91], v[172:175], v[216:219], v[88:91]
v_mfma_f32_16x16x32_bf16 v[88:91], v[192:195], v[148:151], v[88:91]
v_mfma_f32_16x16x32_bf16 v[88:91], v[128:131], v[160:163], v[88:91]
v_mfma_f32_16x16x32_bf16 v[72:75], v[128:131], v[148:151], v[72:75]
v_mfma_f32_16x16x32_bf16 v[72:75], v[192:195], v[216:219], v[72:75]
v_mfma_f32_16x16x32_bf16 v[72:75], v[172:175], v[224:227], v[72:75]
v_mfma_f32_16x16x32_bf16 v[56:59], v[172:175], v[132:135], v[56:59]
v_mfma_f32_16x16x32_bf16 v[56:59], v[192:195], v[224:227], v[56:59]
v_mfma_f32_16x16x32_bf16 v[56:59], v[128:131], v[216:219], v[56:59]
v_mfma_f32_16x16x32_bf16 v[40:43], v[128:131], v[224:227], v[40:43]
v_mfma_f32_16x16x32_bf16 v[40:43], v[192:195], v[132:135], v[40:43]
v_mfma_f32_16x16x32_bf16 v[40:43], v[172:175], v[248:251], v[40:43]
v_mfma_f32_16x16x32_bf16 v[24:27], v[172:175], v[212:215], v[24:27]
v_mfma_f32_16x16x32_bf16 v[24:27], v[192:195], v[248:251], v[24:27]
v_mfma_f32_16x16x32_bf16 v[24:27], v[128:131], v[132:135], v[24:27]
v_mfma_f32_16x16x32_bf16 v[8:11], v[128:131], v[248:251], v[8:11]
v_mfma_f32_16x16x32_bf16 v[8:11], v[192:195], v[212:215], v[8:11]
v_mfma_f32_16x16x32_bf16 v[8:11], v[172:175], v[168:171], v[8:11]
s_waitcnt lgkmcnt(10)
v_mfma_f32_16x16x32_bf16 v[4:7], v[176:179], v[168:171], v[4:7]
s_waitcnt lgkmcnt(8)
v_mfma_f32_16x16x32_bf16 v[4:7], v[196:199], v[212:215], v[4:7]
s_waitcnt lgkmcnt(6)
v_mfma_f32_16x16x32_bf16 v[4:7], v[184:187], v[248:251], v[4:7]
v_mfma_f32_16x16x32_bf16 v[20:23], v[184:187], v[132:135], v[20:23]
v_mfma_f32_16x16x32_bf16 v[20:23], v[196:199], v[248:251], v[20:23]
v_mfma_f32_16x16x32_bf16 v[20:23], v[176:179], v[212:215], v[20:23]
v_mfma_f32_16x16x32_bf16 v[36:39], v[176:179], v[248:251], v[36:39]
v_mfma_f32_16x16x32_bf16 v[36:39], v[196:199], v[132:135], v[36:39]
v_mfma_f32_16x16x32_bf16 v[36:39], v[184:187], v[224:227], v[36:39]
v_mfma_f32_16x16x32_bf16 v[52:55], v[184:187], v[216:219], v[52:55]
v_mfma_f32_16x16x32_bf16 v[52:55], v[196:199], v[224:227], v[52:55]
v_mfma_f32_16x16x32_bf16 v[52:55], v[176:179], v[132:135], v[52:55]
v_mfma_f32_16x16x32_bf16 v[68:71], v[176:179], v[224:227], v[68:71]
v_mfma_f32_16x16x32_bf16 v[68:71], v[196:199], v[216:219], v[68:71]
v_mfma_f32_16x16x32_bf16 v[68:71], v[184:187], v[148:151], v[68:71]
v_mfma_f32_16x16x32_bf16 v[84:87], v[184:187], v[160:163], v[84:87]
v_mfma_f32_16x16x32_bf16 v[84:87], v[196:199], v[148:151], v[84:87]
v_mfma_f32_16x16x32_bf16 v[84:87], v[176:179], v[216:219], v[84:87]
v_mfma_f32_16x16x32_bf16 v[100:103], v[176:179], v[148:151], v[100:103]
v_mfma_f32_16x16x32_bf16 v[100:103], v[196:199], v[160:163], v[100:103]
v_mfma_f32_16x16x32_bf16 v[100:103], v[184:187], v[180:183], v[100:103]
v_mfma_f32_16x16x32_bf16 v[116:119], v[184:187], v[156:159], v[116:119]
v_mfma_f32_16x16x32_bf16 v[116:119], v[196:199], v[180:183], v[116:119]
v_mfma_f32_16x16x32_bf16 v[116:119], v[176:179], v[160:163], v[116:119]
s_waitcnt lgkmcnt(4)
s_barrier
ds_read_b64_tr_b16 v[204:205], v240 offset:18432
v_mfma_f32_16x16x32_bf16 v[124:127], v[164:167], v[160:163], v[124:127]
s_waitcnt lgkmcnt(3)
ds_read_b64_tr_b16 v[206:207], v240 offset:19456
v_mfma_f32_16x16x32_bf16 v[124:127], v[144:147], v[180:183], v[124:127]
s_waitcnt lgkmcnt(2)
ds_read_b128 v[136:139], v238 offset:32768
v_mfma_f32_16x16x32_bf16 v[124:127], v[140:143], v[156:159], v[124:127]
ds_read_b64_tr_b16 v[188:189], v240 offset:20480
v_mfma_f32_16x16x32_bf16 v[108:111], v[140:143], v[180:183], v[108:111]
ds_read_b64_tr_b16 v[190:191], v240 offset:21504
v_mfma_f32_16x16x32_bf16 v[108:111], v[144:147], v[160:163], v[108:111]
ds_read_b128 v[228:231], v238 offset:33024
v_mfma_f32_16x16x32_bf16 v[108:111], v[164:167], v[148:151], v[108:111]
ds_read_b64_tr_b16 v[200:201], v240 offset:22528
v_mfma_f32_16x16x32_bf16 v[92:95], v[164:167], v[216:219], v[92:95]
ds_read_b64_tr_b16 v[202:203], v240 offset:23552
v_mfma_f32_16x16x32_bf16 v[92:95], v[144:147], v[148:151], v[92:95]
ds_read_b128 v[220:223], v238 offset:33280
v_mfma_f32_16x16x32_bf16 v[92:95], v[140:143], v[160:163], v[92:95]
ds_read_b128 v[232:235], v238 offset:33536
v_mfma_f32_16x16x32_bf16 v[76:79], v[140:143], v[148:151], v[76:79]
ds_read_b128 v[152:155], v238 offset:33792
v_mfma_f32_16x16x32_bf16 v[76:79], v[144:147], v[216:219], v[76:79]
ds_read_b128 v[208:211], v238 offset:34048
v_mfma_f32_16x16x32_bf16 v[76:79], v[164:167], v[224:227], v[76:79]
ds_read_b128 v[128:131], v238 offset:34304
v_mfma_f32_16x16x32_bf16 v[60:63], v[164:167], v[132:135], v[60:63]
ds_read_b128 v[192:195], v238 offset:34560
v_mfma_f32_16x16x32_bf16 v[60:63], v[144:147], v[224:227], v[60:63]
ds_read_b128 v[172:175], v239 offset:32768
v_mfma_f32_16x16x32_bf16 v[60:63], v[140:143], v[216:219], v[60:63]
ds_read_b128 v[184:187], v239 offset:33024
v_mfma_f32_16x16x32_bf16 v[44:47], v[140:143], v[224:227], v[44:47]
ds_read_b64_tr_b16 v[196:197], v242 offset:18432
v_mfma_f32_16x16x32_bf16 v[44:47], v[144:147], v[132:135], v[44:47]
L_pad1:
s_cmp_eq_u32 s79, 1
s_cbranch_scc1 L_lret1
ds_read_b64_tr_b16 v[198:199], v242 offset:19456
v_mfma_f32_16x16x32_bf16 v[44:47], v[164:167], v[248:251], v[44:47]
ds_read_b64_tr_b16 v[176:177], v242 offset:20480
v_mfma_f32_16x16x32_bf16 v[28:31], v[164:167], v[212:215], v[28:31]
ds_read_b64_tr_b16 v[178:179], v242 offset:21504
v_mfma_f32_16x16x32_bf16 v[28:31], v[144:147], v[248:251], v[28:31]
ds_read_b64_tr_b16 v[156:157], v242 offset:22528
v_mfma_f32_16x16x32_bf16 v[28:31], v[140:143], v[132:135], v[28:31]
ds_read_b64_tr_b16 v[158:159], v242 offset:23552
v_mfma_f32_16x16x32_bf16 v[12:15], v[140:143], v[248:251], v[12:15]
v_mfma_f32_16x16x32_bf16 v[12:15], v[144:147], v[212:215], v[12:15]
v_mfma_f32_16x16x32_bf16 v[12:15], v[164:167], v[168:171], v[12:15]
s_waitcnt lgkmcnt(14)
v_mfma_f32_16x16x32_bf16 v[0:3], v[204:207], v[136:139], v[0:3]
ds_read_b64_tr_b16 v[180:181], v241 offset:18432
v_mfma_f32_16x16x32_bf16 v[0:3], v[188:191], v[228:231], v[0:3]
s_waitcnt lgkmcnt(14)
ds_read_b64_tr_b16 v[182:183], v241 offset:19456
v_mfma_f32_16x16x32_bf16 v[0:3], v[200:203], v[220:223], v[0:3]
s_waitcnt lgkmcnt(14)
ds_read_b64_tr_b16 v[160:161], v241 offset:20480
v_mfma_f32_16x16x32_bf16 v[16:19], v[200:203], v[232:235], v[16:19]
ds_read_b64_tr_b16 v[162:163], v241 offset:21504
v_mfma_f32_16x16x32_bf16 v[16:19], v[188:191], v[220:223], v[16:19]
ds_read_b64_tr_b16 v[148:149], v241 offset:22528
v_mfma_f32_16x16x32_bf16 v[16:19], v[204:207], v[228:231], v[16:19]
ds_read_b64_tr_b16 v[150:151], v241 offset:23552
v_mfma_f32_16x16x32_bf16 v[32:35], v[204:207], v[220:223], v[32:35]
v_mfma_f32_16x16x32_bf16 v[32:35], v[188:191], v[232:235], v[32:35]
s_waitcnt lgkmcnt(14)
v_mfma_f32_16x16x32_bf16 v[32:35], v[200:203], v[152:155], v[32:35]
v_mfma_f32_16x16x32_bf16 v[48:51], v[200:203], v[208:211], v[48:51]
v_mfma_f32_16x16x32_bf16 v[48:51], v[188:191], v[152:155], v[48:51]
v_mfma_f32_16x16x32_bf16 v[48:51], v[204:207], v[232:235], v[48:51]
v_mfma_f32_16x16x32_bf16 v[64:67], v[204:207], v[152:155], v[64:67]
v_mfma_f32_16x16x32_bf16 v[64:67], v[188:191], v[208:211], v[64:67]
v_mfma_f32_16x16x32_bf16 v[64:67], v[200:203], v[128:131], v[64:67]
v_mfma_f32_16x16x32_bf16 v[80:83], v[200:203], v[192:195], v[80:83]
v_mfma_f32_16x16x32_bf16 v[80:83], v[188:191], v[128:131], v[80:83]
v_mfma_f32_16x16x32_bf16 v[80:83], v[204:207], v[208:211], v[80:83]
v_mfma_f32_16x16x32_bf16 v[96:99], v[204:207], v[128:131], v[96:99]
v_mfma_f32_16x16x32_bf16 v[96:99], v[188:191], v[192:195], v[96:99]
s_waitcnt lgkmcnt(13)
v_mfma_f32_16x16x32_bf16 v[96:99], v[200:203], v[172:175], v[96:99]
s_waitcnt lgkmcnt(12)
v_mfma_f32_16x16x32_bf16 v[112:115], v[200:203], v[184:187], v[112:115]
v_mfma_f32_16x16x32_bf16 v[112:115], v[188:191], v[172:175], v[112:115]
v_mfma_f32_16x16x32_bf16 v[112:115], v[204:207], v[192:195], v[112:115]
s_waitcnt lgkmcnt(10)
v_mfma_f32_16x16x32_bf16 v[120:123], v[196:199], v[192:195], v[120:123]
s_waitcnt lgkmcnt(8)
ds_read_b64_tr_b16 v[216:217], v243 offset:18432
v_mfma_f32_16x16x32_bf16 v[120:123], v[176:179], v[172:175], v[120:123]
s_waitcnt lgkmcnt(7)
ds_read_b64_tr_b16 v[218:219], v243 offset:19456
v_mfma_f32_16x16x32_bf16 v[120:123], v[156:159], v[184:187], v[120:123]
ds_read_b64_tr_b16 v[224:225], v243 offset:20480
v_mfma_f32_16x16x32_bf16 v[104:107], v[156:159], v[172:175], v[104:107]
ds_read_b64_tr_b16 v[226:227], v243 offset:21504
v_mfma_f32_16x16x32_bf16 v[104:107], v[176:179], v[192:195], v[104:107]
ds_read_b64_tr_b16 v[132:133], v243 offset:22528
v_mfma_f32_16x16x32_bf16 v[104:107], v[196:199], v[128:131], v[104:107]
ds_read_b64_tr_b16 v[134:135], v243 offset:23552
v_mfma_f32_16x16x32_bf16 v[88:91], v[196:199], v[208:211], v[88:91]
v_mfma_f32_16x16x32_bf16 v[88:91], v[176:179], v[128:131], v[88:91]
v_mfma_f32_16x16x32_bf16 v[88:91], v[156:159], v[192:195], v[88:91]
v_mfma_f32_16x16x32_bf16 v[72:75], v[156:159], v[128:131], v[72:75]
v_mfma_f32_16x16x32_bf16 v[72:75], v[176:179], v[208:211], v[72:75]
v_mfma_f32_16x16x32_bf16 v[72:75], v[196:199], v[152:155], v[72:75]
v_mfma_f32_16x16x32_bf16 v[56:59], v[196:199], v[232:235], v[56:59]
v_mfma_f32_16x16x32_bf16 v[56:59], v[176:179], v[152:155], v[56:59]
v_mfma_f32_16x16x32_bf16 v[56:59], v[156:159], v[208:211], v[56:59]
v_mfma_f32_16x16x32_bf16 v[40:43], v[156:159], v[152:155], v[40:43]
v_mfma_f32_16x16x32_bf16 v[40:43], v[176:179], v[232:235], v[40:43]
v_mfma_f32_16x16x32_bf16 v[40:43], v[196:199], v[220:223], v[40:43]
v_mfma_f32_16x16x32_bf16 v[24:27], v[196:199], v[228:231], v[24:27]
v_mfma_f32_16x16x32_bf16 v[24:27], v[176:179], v[220:223], v[24:27]
v_mfma_f32_16x16x32_bf16 v[24:27], v[156:159], v[232:235], v[24:27]
v_mfma_f32_16x16x32_bf16 v[8:11], v[156:159], v[220:223], v[8:11]
v_mfma_f32_16x16x32_bf16 v[8:11], v[176:179], v[228:231], v[8:11]
v_mfma_f32_16x16x32_bf16 v[8:11], v[196:199], v[136:139], v[8:11]
s_waitcnt lgkmcnt(10)
v_mfma_f32_16x16x32_bf16 v[4:7], v[180:183], v[136:139], v[4:7]
s_waitcnt lgkmcnt(8)
v_mfma_f32_16x16x32_bf16 v[4:7], v[160:163], v[228:231], v[4:7]
s_waitcnt lgkmcnt(6)
v_mfma_f32_16x16x32_bf16 v[4:7], v[148:151], v[220:223], v[4:7]
v_mfma_f32_16x16x32_bf16 v[20:23], v[148:151], v[232:235], v[20:23]
v_mfma_f32_16x16x32_bf16 v[20:23], v[160:163], v[220:223], v[20:23]
v_mfma_f32_16x16x32_bf16 v[20:23], v[180:183], v[228:231], v[20:23]
v_mfma_f32_16x16x32_bf16 v[36:39], v[180:183], v[220:223], v[36:39]
v_mfma_f32_16x16x32_bf16 v[36:39], v[160:163], v[232:235], v[36:39]
v_mfma_f32_16x16x32_bf16 v[36:39], v[148:151], v[152:155], v[36:39]
v_mfma_f32_16x16x32_bf16 v[52:55], v[148:151], v[208:211], v[52:55]
v_mfma_f32_16x16x32_bf16 v[52:55], v[160:163], v[152:155], v[52:55]
v_mfma_f32_16x16x32_bf16 v[52:55], v[180:183], v[232:235], v[52:55]
v_mfma_f32_16x16x32_bf16 v[68:71], v[180:183], v[152:155], v[68:71]
v_mfma_f32_16x16x32_bf16 v[68:71], v[160:163], v[208:211], v[68:71]
v_mfma_f32_16x16x32_bf16 v[68:71], v[148:151], v[128:131], v[68:71]
v_mfma_f32_16x16x32_bf16 v[84:87], v[148:151], v[192:195], v[84:87]
v_mfma_f32_16x16x32_bf16 v[84:87], v[160:163], v[128:131], v[84:87]
v_mfma_f32_16x16x32_bf16 v[84:87], v[180:183], v[208:211], v[84:87]
v_mfma_f32_16x16x32_bf16 v[100:103], v[180:183], v[128:131], v[100:103]
v_mfma_f32_16x16x32_bf16 v[100:103], v[160:163], v[192:195], v[100:103]
v_mfma_f32_16x16x32_bf16 v[100:103], v[148:151], v[172:175], v[100:103]
v_mfma_f32_16x16x32_bf16 v[116:119], v[148:151], v[184:187], v[116:119]
v_mfma_f32_16x16x32_bf16 v[116:119], v[160:163], v[172:175], v[116:119]
v_mfma_f32_16x16x32_bf16 v[116:119], v[180:183], v[192:195], v[116:119]
s_waitcnt lgkmcnt(4)
s_barrier
ds_read_b64_tr_b16 v[140:141], v240 offset:0
v_mfma_f32_16x16x32_bf16 v[124:127], v[216:219], v[192:195], v[124:127]
s_waitcnt lgkmcnt(3)
ds_read_b64_tr_b16 v[142:143], v240 offset:1024
v_mfma_f32_16x16x32_bf16 v[124:127], v[224:227], v[172:175], v[124:127]
s_waitcnt lgkmcnt(2)
ds_read_b128 v[248:251], v236 offset:0
v_mfma_f32_16x16x32_bf16 v[124:127], v[132:135], v[184:187], v[124:127]
ds_read_b64_tr_b16 v[144:145], v240 offset:2048
v_mfma_f32_16x16x32_bf16 v[108:111], v[132:135], v[172:175], v[108:111]
ds_read_b64_tr_b16 v[146:147], v240 offset:3072
v_mfma_f32_16x16x32_bf16 v[108:111], v[224:227], v[192:195], v[108:111]
ds_read_b128 v[212:215], v236 offset:256
v_mfma_f32_16x16x32_bf16 v[108:111], v[216:219], v[128:131], v[108:111]
ds_read_b64_tr_b16 v[164:165], v240 offset:4096
v_mfma_f32_16x16x32_bf16 v[92:95], v[216:219], v[208:211], v[92:95]
ds_read_b64_tr_b16 v[166:167], v240 offset:5120
v_mfma_f32_16x16x32_bf16 v[92:95], v[224:227], v[128:131], v[92:95]
ds_read_b128 v[168:171], v236 offset:512
v_mfma_f32_16x16x32_bf16 v[92:95], v[132:135], v[192:195], v[92:95]
ds_read_b128 v[200:203], v236 offset:768
v_mfma_f32_16x16x32_bf16 v[76:79], v[132:135], v[128:131], v[76:79]
ds_read_b128 v[188:191], v236 offset:1024
v_mfma_f32_16x16x32_bf16 v[76:79], v[224:227], v[208:211], v[76:79]
ds_read_b128 v[204:207], v236 offset:1280
v_mfma_f32_16x16x32_bf16 v[76:79], v[216:219], v[152:155], v[76:79]
ds_read_b128 v[156:159], v236 offset:1536
v_mfma_f32_16x16x32_bf16 v[60:63], v[216:219], v[232:235], v[60:63]
ds_read_b128 v[176:179], v236 offset:1792
v_mfma_f32_16x16x32_bf16 v[60:63], v[224:227], v[152:155], v[60:63]
ds_read_b128 v[196:199], v237 offset:0
v_mfma_f32_16x16x32_bf16 v[60:63], v[132:135], v[208:211], v[60:63]
ds_read_b128 v[148:151], v237 offset:256
v_mfma_f32_16x16x32_bf16 v[44:47], v[132:135], v[152:155], v[44:47]
ds_read_b64_tr_b16 v[160:161], v242 offset:0
v_mfma_f32_16x16x32_bf16 v[44:47], v[224:227], v[232:235], v[44:47]
ds_read_b64_tr_b16 v[162:163], v242 offset:1024
v_mfma_f32_16x16x32_bf16 v[44:47], v[216:219], v[220:223], v[44:47]
ds_read_b64_tr_b16 v[180:181], v242 offset:2048
v_mfma_f32_16x16x32_bf16 v[28:31], v[216:219], v[228:231], v[28:31]
ds_read_b64_tr_b16 v[182:183], v242 offset:3072
v_mfma_f32_16x16x32_bf16 v[28:31], v[224:227], v[220:223], v[28:31]
ds_read_b64_tr_b16 v[184:185], v242 offset:4096
v_mfma_f32_16x16x32_bf16 v[28:31], v[132:135], v[232:235], v[28:31]
ds_read_b64_tr_b16 v[186:187], v242 offset:5120
v_mfma_f32_16x16x32_bf16 v[12:15], v[132:135], v[220:223], v[12:15]
v_mfma_f32_16x16x32_bf16 v[12:15], v[224:227], v[228:231], v[12:15]
v_mfma_f32_16x16x32_bf16 v[12:15], v[216:219], v[136:139], v[12:15]
s_waitcnt lgkmcnt(14)
v_mfma_f32_16x16x32_bf16 v[0:3], v[140:143], v[248:251], v[0:3]
ds_read_b64_tr_b16 v[172:173], v241 offset:0
v_mfma_f32_16x16x32_bf16 v[0:3], v[144:147], v[212:215], v[0:3]
s_waitcnt lgkmcnt(14)
ds_read_b64_tr_b16 v[174:175], v241 offset:1024
v_mfma_f32_16x16x32_bf16 v[0:3], v[164:167], v[168:171], v[0:3]
s_waitcnt lgkmcnt(14)
ds_read_b64_tr_b16 v[192:193], v241 offset:2048
v_mfma_f32_16x16x32_bf16 v[16:19], v[164:167], v[200:203], v[16:19]
ds_read_b64_tr_b16 v[194:195], v241 offset:3072
v_mfma_f32_16x16x32_bf16 v[16:19], v[144:147], v[168:171], v[16:19]
ds_read_b64_tr_b16 v[128:129], v241 offset:4096
v_mfma_f32_16x16x32_bf16 v[16:19], v[140:143], v[212:215], v[16:19]
ds_read_b64_tr_b16 v[130:131], v241 offset:5120
v_mfma_f32_16x16x32_bf16 v[32:35], v[140:143], v[168:171], v[32:35]
v_mfma_f32_16x16x32_bf16 v[32:35], v[144:147], v[200:203], v[32:35]
s_waitcnt lgkmcnt(14)
v_mfma_f32_16x16x32_bf16 v[32:35], v[164:167], v[188:191], v[32:35]
v_mfma_f32_16x16x32_bf16 v[48:51], v[164:167], v[204:207], v[48:51]
v_mfma_f32_16x16x32_bf16 v[48:51], v[144:147], v[188:191], v[48:51]
v_mfma_f32_16x16x32_bf16 v[48:51], v[140:143], v[200:203], v[48:51]
v_mfma_f32_16x16x32_bf16 v[64:67], v[140:143], v[188:191], v[64:67]
v_mfma_f32_16x16x32_bf16 v[64:67], v[144:147], v[204:207], v[64:67]
v_mfma_f32_16x16x32_bf16 v[64:67], v[164:167], v[156:159], v[64:67]
v_mfma_f32_16x16x32_bf16 v[80:83], v[164:167], v[176:179], v[80:83]
v_mfma_f32_16x16x32_bf16 v[80:83], v[144:147], v[156:159], v[80:83]
v_mfma_f32_16x16x32_bf16 v[80:83], v[140:143], v[204:207], v[80:83]
v_mfma_f32_16x16x32_bf16 v[96:99], v[140:143], v[156:159], v[96:99]
v_mfma_f32_16x16x32_bf16 v[96:99], v[144:147], v[176:179], v[96:99]
s_waitcnt lgkmcnt(13)
v_mfma_f32_16x16x32_bf16 v[96:99], v[164:167], v[196:199], v[96:99]
s_waitcnt lgkmcnt(12)
v_mfma_f32_16x16x32_bf16 v[112:115], v[164:167], v[148:151], v[112:115]
v_mfma_f32_16x16x32_bf16 v[112:115], v[144:147], v[196:199], v[112:115]
v_mfma_f32_16x16x32_bf16 v[112:115], v[140:143], v[176:179], v[112:115]
s_waitcnt lgkmcnt(10)
v_mfma_f32_16x16x32_bf16 v[120:123], v[160:163], v[176:179], v[120:123]
s_waitcnt lgkmcnt(8)
ds_read_b64_tr_b16 v[208:209], v243 offset:0
v_mfma_f32_16x16x32_bf16 v[120:123], v[180:183], v[196:199], v[120:123]
s_waitcnt lgkmcnt(7)
ds_read_b64_tr_b16 v[210:211], v243 offset:1024
v_mfma_f32_16x16x32_bf16 v[120:123], v[184:187], v[148:151], v[120:123]
ds_read_b64_tr_b16 v[152:153], v243 offset:2048
v_mfma_f32_16x16x32_bf16 v[104:107], v[184:187], v[196:199], v[104:107]
ds_read_b64_tr_b16 v[154:155], v243 offset:3072
v_mfma_f32_16x16x32_bf16 v[104:107], v[180:183], v[176:179], v[104:107]
ds_read_b64_tr_b16 v[232:233], v243 offset:4096
v_mfma_f32_16x16x32_bf16 v[104:107], v[160:163], v[156:159], v[104:107]
ds_read_b64_tr_b16 v[234:235], v243 offset:5120
v_mfma_f32_16x16x32_bf16 v[88:91], v[160:163], v[204:207], v[88:91]
v_mfma_f32_16x16x32_bf16 v[88:91], v[180:183], v[156:159], v[88:91]
v_mfma_f32_16x16x32_bf16 v[88:91], v[184:187], v[176:179], v[88:91]
v_mfma_f32_16x16x32_bf16 v[72:75], v[184:187], v[156:159], v[72:75]
v_mfma_f32_16x16x32_bf16 v[72:75], v[180:183], v[204:207], v[72:75]
v_mfma_f32_16x16x32_bf16 v[72:75], v[160:163], v[188:191], v[72:75]
v_mfma_f32_16x16x32_bf16 v[56:59], v[160:163], v[200:203], v[56:59]
v_mfma_f32_16x16x32_bf16 v[56:59], v[180:183], v[188:191], v[56:59]
v_mfma_f32_16x16x32_bf16 v[56:59], v[184:187], v[204:207], v[56:59]
v_mfma_f32_16x16x32_bf16 v[40:43], v[184:187], v[188:191], v[40:43]
v_mfma_f32_16x16x32_bf16 v[40:43], v[180:183], v[200:203], v[40:43]
v_mfma_f32_16x16x32_bf16 v[40:43], v[160:163], v[168:171], v[40:43]
v_mfma_f32_16x16x32_bf16 v[24:27], v[160:163], v[212:215], v[24:27]
v_mfma_f32_16x16x32_bf16 v[24:27], v[180:183], v[168:171], v[24:27]
v_mfma_f32_16x16x32_bf16 v[24:27], v[184:187], v[200:203], v[24:27]
v_mfma_f32_16x16x32_bf16 v[8:11], v[184:187], v[168:171], v[8:11]
v_mfma_f32_16x16x32_bf16 v[8:11], v[180:183], v[212:215], v[8:11]
v_mfma_f32_16x16x32_bf16 v[8:11], v[160:163], v[248:251], v[8:11]
s_waitcnt lgkmcnt(10)
v_mfma_f32_16x16x32_bf16 v[4:7], v[172:175], v[248:251], v[4:7]
s_waitcnt lgkmcnt(8)
v_mfma_f32_16x16x32_bf16 v[4:7], v[192:195], v[212:215], v[4:7]
s_waitcnt lgkmcnt(6)
v_mfma_f32_16x16x32_bf16 v[4:7], v[128:131], v[168:171], v[4:7]
v_mfma_f32_16x16x32_bf16 v[20:23], v[128:131], v[200:203], v[20:23]
v_mfma_f32_16x16x32_bf16 v[20:23], v[192:195], v[168:171], v[20:23]
v_mfma_f32_16x16x32_bf16 v[20:23], v[172:175], v[212:215], v[20:23]
v_mfma_f32_16x16x32_bf16 v[36:39], v[172:175], v[168:171], v[36:39]
v_mfma_f32_16x16x32_bf16 v[36:39], v[192:195], v[200:203], v[36:39]
v_mfma_f32_16x16x32_bf16 v[36:39], v[128:131], v[188:191], v[36:39]
v_mfma_f32_16x16x32_bf16 v[52:55], v[128:131], v[204:207], v[52:55]
v_mfma_f32_16x16x32_bf16 v[52:55], v[192:195], v[188:191], v[52:55]
v_mfma_f32_16x16x32_bf16 v[52:55], v[172:175], v[200:203], v[52:55]
v_mfma_f32_16x16x32_bf16 v[68:71], v[172:175], v[188:191], v[68:71]
v_mfma_f32_16x16x32_bf16 v[68:71], v[192:195], v[204:207], v[68:71]
v_mfma_f32_16x16x32_bf16 v[68:71], v[128:131], v[156:159], v[68:71]
v_mfma_f32_16x16x32_bf16 v[84:87], v[128:131], v[176:179], v[84:87]
v_mfma_f32_16x16x32_bf16 v[84:87], v[192:195], v[156:159], v[84:87]
v_mfma_f32_16x16x32_bf16 v[84:87], v[172:175], v[204:207], v[84:87]
v_mfma_f32_16x16x32_bf16 v[100:103], v[172:175], v[156:159], v[100:103]
v_mfma_f32_16x16x32_bf16 v[100:103], v[192:195], v[176:179], v[100:103]
v_mfma_f32_16x16x32_bf16 v[100:103], v[128:131], v[196:199], v[100:103]
v_mfma_f32_16x16x32_bf16 v[116:119], v[128:131], v[148:151], v[116:119]
v_mfma_f32_16x16x32_bf16 v[116:119], v[192:195], v[196:199], v[116:119]
v_mfma_f32_16x16x32_bf16 v[116:119], v[172:175], v[176:179], v[116:119]
s_waitcnt lgkmcnt(4)
s_barrier
ds_read_b64_tr_b16 v[132:133], v240 offset:6144
v_mfma_f32_16x16x32_bf16 v[124:127], v[208:211], v[176:179], v[124:127]
s_waitcnt lgkmcnt(3)
ds_read_b64_tr_b16 v[134:135], v240 offset:7168
v_mfma_f32_16x16x32_bf16 v[124:127], v[152:155], v[196:199], v[124:127]
s_waitcnt lgkmcnt(2)
ds_read_b128 v[220:223], v238 offset:0
v_mfma_f32_16x16x32_bf16 v[124:127], v[232:235], v[148:151], v[124:127]
ds_read_b64_tr_b16 v[224:225], v240 offset:8192
v_mfma_f32_16x16x32_bf16 v[108:111], v[232:235], v[196:199], v[108:111]
ds_read_b64_tr_b16 v[226:227], v240 offset:9216
v_mfma_f32_16x16x32_bf16 v[108:111], v[152:155], v[176:179], v[108:111]
ds_read_b128 v[228:231], v238 offset:256
v_mfma_f32_16x16x32_bf16 v[108:111], v[208:211], v[156:159], v[108:111]
ds_read_b64_tr_b16 v[216:217], v240 offset:10240
v_mfma_f32_16x16x32_bf16 v[92:95], v[208:211], v[204:207], v[92:95]
ds_read_b64_tr_b16 v[218:219], v240 offset:11264
v_mfma_f32_16x16x32_bf16 v[92:95], v[152:155], v[156:159], v[92:95]
ds_read_b128 v[136:139], v238 offset:512
v_mfma_f32_16x16x32_bf16 v[92:95], v[232:235], v[176:179], v[92:95]
ds_read_b128 v[164:167], v238 offset:768
v_mfma_f32_16x16x32_bf16 v[76:79], v[232:235], v[156:159], v[76:79]
ds_read_b128 v[144:147], v238 offset:1024
v_mfma_f32_16x16x32_bf16 v[76:79], v[152:155], v[204:207], v[76:79]
ds_read_b128 v[140:143], v238 offset:1280
v_mfma_f32_16x16x32_bf16 v[76:79], v[208:211], v[188:191], v[76:79]
ds_read_b128 v[184:187], v238 offset:1536
v_mfma_f32_16x16x32_bf16 v[60:63], v[208:211], v[200:203], v[60:63]
ds_read_b128 v[180:183], v238 offset:1792
v_mfma_f32_16x16x32_bf16 v[60:63], v[152:155], v[188:191], v[60:63]
ds_read_b128 v[160:163], v239 offset:0
v_mfma_f32_16x16x32_bf16 v[60:63], v[232:235], v[204:207], v[60:63]
ds_read_b128 v[128:131], v239 offset:256
v_mfma_f32_16x16x32_bf16 v[44:47], v[232:235], v[188:191], v[44:47]
ds_read_b64_tr_b16 v[192:193], v242 offset:6144
v_mfma_f32_16x16x32_bf16 v[44:47], v[152:155], v[200:203], v[44:47]
ds_read_b64_tr_b16 v[194:195], v242 offset:7168
v_mfma_f32_16x16x32_bf16 v[44:47], v[208:211], v[168:171], v[44:47]
ds_read_b64_tr_b16 v[172:173], v242 offset:8192
v_mfma_f32_16x16x32_bf16 v[28:31], v[208:211], v[212:215], v[28:31]
ds_read_b64_tr_b16 v[174:175], v242 offset:9216
v_mfma_f32_16x16x32_bf16 v[28:31], v[152:155], v[168:171], v[28:31]
ds_read_b64_tr_b16 v[148:149], v242 offset:10240
v_mfma_f32_16x16x32_bf16 v[28:31], v[232:235], v[200:203], v[28:31]
ds_read_b64_tr_b16 v[150:151], v242 offset:11264
v_mfma_f32_16x16x32_bf16 v[12:15], v[232:235], v[168:171], v[12:15]
v_mfma_f32_16x16x32_bf16 v[12:15], v[152:155], v[212:215], v[12:15]
v_mfma_f32_16x16x32_bf16 v[12:15], v[208:211], v[248:251], v[12:15]
s_waitcnt lgkmcnt(14)
v_mfma_f32_16x16x32_bf16 v[0:3], v[132:135], v[220:223], v[0:3]
ds_read_b64_tr_b16 v[196:197], v241 offset:6144
v_mfma_f32_16x16x32_bf16 v[0:3], v[224:227], v[228:231], v[0:3]
s_waitcnt lgkmcnt(14)
ds_read_b64_tr_b16 v[198:199], v241 offset:7168
v_mfma_f32_16x16x32_bf16 v[0:3], v[216:219], v[136:139], v[0:3]
s_waitcnt lgkmcnt(14)
ds_read_b64_tr_b16 v[176:177], v241 offset:8192
v_mfma_f32_16x16x32_bf16 v[16:19], v[216:219], v[164:167], v[16:19]
ds_read_b64_tr_b16 v[178:179], v241 offset:9216
v_mfma_f32_16x16x32_bf16 v[16:19], v[224:227], v[136:139], v[16:19]
ds_read_b64_tr_b16 v[156:157], v241 offset:10240
v_mfma_f32_16x16x32_bf16 v[16:19], v[132:135], v[228:231], v[16:19]
ds_read_b64_tr_b16 v[158:159], v241 offset:11264
v_mfma_f32_16x16x32_bf16 v[32:35], v[132:135], v[136:139], v[32:35]
v_mfma_f32_16x16x32_bf16 v[32:35], v[224:227], v[164:167], v[32:35]
s_waitcnt lgkmcnt(14)
v_mfma_f32_16x16x32_bf16 v[32:35], v[216:219], v[144:147], v[32:35]
v_mfma_f32_16x16x32_bf16 v[48:51], v[216:219], v[140:143], v[48:51]
v_mfma_f32_16x16x32_bf16 v[48:51], v[224:227], v[144:147], v[48:51]
v_mfma_f32_16x16x32_bf16 v[48:51], v[132:135], v[164:167], v[48:51]
v_mfma_f32_16x16x32_bf16 v[64:67], v[132:135], v[144:147], v[64:67]
v_mfma_f32_16x16x32_bf16 v[64:67], v[224:227], v[140:143], v[64:67]
v_mfma_f32_16x16x32_bf16 v[64:67], v[216:219], v[184:187], v[64:67]
v_mfma_f32_16x16x32_bf16 v[80:83], v[216:219], v[180:183], v[80:83]
v_mfma_f32_16x16x32_bf16 v[80:83], v[224:227], v[184:187], v[80:83]
v_mfma_f32_16x16x32_bf16 v[80:83], v[132:135], v[140:143], v[80:83]
v_mfma_f32_16x16x32_bf16 v[96:99], v[132:135], v[184:187], v[96:99]
v_mfma_f32_16x16x32_bf16 v[96:99], v[224:227], v[180:183], v[96:99]
s_waitcnt lgkmcnt(13)
v_mfma_f32_16x16x32_bf16 v[96:99], v[216:219], v[160:163], v[96:99]
s_waitcnt lgkmcnt(12)
v_mfma_f32_16x16x32_bf16 v[112:115], v[216:219], v[128:131], v[112:115]
v_mfma_f32_16x16x32_bf16 v[112:115], v[224:227], v[160:163], v[112:115]
v_mfma_f32_16x16x32_bf16 v[112:115], v[132:135], v[180:183], v[112:115]
s_waitcnt lgkmcnt(10)
v_mfma_f32_16x16x32_bf16 v[120:123], v[192:195], v[180:183], v[120:123]
s_waitcnt lgkmcnt(8)
ds_read_b64_tr_b16 v[204:205], v243 offset:6144
v_mfma_f32_16x16x32_bf16 v[120:123], v[172:175], v[160:163], v[120:123]
s_waitcnt lgkmcnt(7)
ds_read_b64_tr_b16 v[206:207], v243 offset:7168
v_mfma_f32_16x16x32_bf16 v[120:123], v[148:151], v[128:131], v[120:123]
ds_read_b64_tr_b16 v[188:189], v243 offset:8192
v_mfma_f32_16x16x32_bf16 v[104:107], v[148:151], v[160:163], v[104:107]
ds_read_b64_tr_b16 v[190:191], v243 offset:9216
v_mfma_f32_16x16x32_bf16 v[104:107], v[172:175], v[180:183], v[104:107]
ds_read_b64_tr_b16 v[200:201], v243 offset:10240
v_mfma_f32_16x16x32_bf16 v[104:107], v[192:195], v[184:187], v[104:107]
ds_read_b64_tr_b16 v[202:203], v243 offset:11264
v_mfma_f32_16x16x32_bf16 v[88:91], v[192:195], v[140:143], v[88:91]
v_mfma_f32_16x16x32_bf16 v[88:91], v[172:175], v[184:187], v[88:91]
v_mfma_f32_16x16x32_bf16 v[88:91], v[148:151], v[180:183], v[88:91]
v_mfma_f32_16x16x32_bf16 v[72:75], v[148:151], v[184:187], v[72:75]
v_mfma_f32_16x16x32_bf16 v[72:75], v[172:175], v[140:143], v[72:75]
v_mfma_f32_16x16x32_bf16 v[72:75], v[192:195], v[144:147], v[72:75]
v_mfma_f32_16x16x32_bf16 v[56:59], v[192:195], v[164:167], v[56:59]
v_mfma_f32_16x16x32_bf16 v[56:59], v[172:175], v[144:147], v[56:59]
v_mfma_f32_16x16x32_bf16 v[56:59], v[148:151], v[140:143], v[56:59]
v_mfma_f32_16x16x32_bf16 v[40:43], v[148:151], v[144:147], v[40:43]
v_mfma_f32_16x16x32_bf16 v[40:43], v[172:175], v[164:167], v[40:43]
v_mfma_f32_16x16x32_bf16 v[40:43], v[192:195], v[136:139], v[40:43]
v_mfma_f32_16x16x32_bf16 v[24:27], v[192:195], v[228:231], v[24:27]
v_mfma_f32_16x16x32_bf16 v[24:27], v[172:175], v[136:139], v[24:27]
v_mfma_f32_16x16x32_bf16 v[24:27], v[148:151], v[164:167], v[24:27]
v_mfma_f32_16x16x32_bf16 v[8:11], v[148:151], v[136:139], v[8:11]
v_mfma_f32_16x16x32_bf16 v[8:11], v[172:175], v[228:231], v[8:11]
v_mfma_f32_16x16x32_bf16 v[8:11], v[192:195], v[220:223], v[8:11]
s_waitcnt lgkmcnt(10)
v_mfma_f32_16x16x32_bf16 v[4:7], v[196:199], v[220:223], v[4:7]
s_waitcnt lgkmcnt(8)
v_mfma_f32_16x16x32_bf16 v[4:7], v[176:179], v[228:231], v[4:7]
s_waitcnt lgkmcnt(6)
v_mfma_f32_16x16x32_bf16 v[4:7], v[156:159], v[136:139], v[4:7]
v_mfma_f32_16x16x32_bf16 v[20:23], v[156:159], v[164:167], v[20:23]
v_mfma_f32_16x16x32_bf16 v[20:23], v[176:179], v[136:139], v[20:23]
v_mfma_f32_16x16x32_bf16 v[20:23], v[196:199], v[228:231], v[20:23]
v_mfma_f32_16x16x32_bf16 v[36:39], v[196:199], v[136:139], v[36:39]
v_mfma_f32_16x16x32_bf16 v[36:39], v[176:179], v[164:167], v[36:39]
v_mfma_f32_16x16x32_bf16 v[36:39], v[156:159], v[144:147], v[36:39]
v_mfma_f32_16x16x32_bf16 v[52:55], v[156:159], v[140:143], v[52:55]
v_mfma_f32_16x16x32_bf16 v[52:55], v[176:179], v[144:147], v[52:55]
v_mfma_f32_16x16x32_bf16 v[52:55], v[196:199], v[164:167], v[52:55]
v_mfma_f32_16x16x32_bf16 v[68:71], v[196:199], v[144:147], v[68:71]
v_mfma_f32_16x16x32_bf16 v[68:71], v[176:179], v[140:143], v[68:71]
v_mfma_f32_16x16x32_bf16 v[68:71], v[156:159], v[184:187], v[68:71]
v_mfma_f32_16x16x32_bf16 v[84:87], v[156:159], v[180:183], v[84:87]
v_mfma_f32_16x16x32_bf16 v[84:87], v[176:179], v[184:187], v[84:87]
v_mfma_f32_16x16x32_bf16 v[84:87], v[196:199], v[140:143], v[84:87]
v_mfma_f32_16x16x32_bf16 v[100:103], v[196:199], v[184:187], v[100:103]
v_mfma_f32_16x16x32_bf16 v[100:103], v[176:179], v[180:183], v[100:103]
v_mfma_f32_16x16x32_bf16 v[100:103], v[156:159], v[160:163], v[100:103]
v_mfma_f32_16x16x32_bf16 v[116:119], v[156:159], v[128:131], v[116:119]
v_mfma_f32_16x16x32_bf16 v[116:119], v[176:179], v[160:163], v[116:119]
v_mfma_f32_16x16x32_bf16 v[116:119], v[196:199], v[180:183], v[116:119]
s_waitcnt lgkmcnt(4)
s_barrier
ds_read_b64_tr_b16 v[232:233], v240 offset:12288
v_mfma_f32_16x16x32_bf16 v[124:127], v[204:207], v[180:183], v[124:127]
s_waitcnt lgkmcnt(3)
ds_read_b64_tr_b16 v[234:235], v240 offset:13312
v_mfma_f32_16x16x32_bf16 v[124:127], v[188:191], v[160:163], v[124:127]
s_waitcnt lgkmcnt(2)
ds_read_b128 v[168:171], v236 offset:32768
v_mfma_f32_16x16x32_bf16 v[124:127], v[200:203], v[128:131], v[124:127]
ds_read_b64_tr_b16 v[152:153], v240 offset:14336
v_mfma_f32_16x16x32_bf16 v[108:111], v[200:203], v[160:163], v[108:111]
ds_read_b64_tr_b16 v[154:155], v240 offset:15360
v_mfma_f32_16x16x32_bf16 v[108:111], v[188:191], v[180:183], v[108:111]
ds_read_b128 v[212:215], v236 offset:33024
v_mfma_f32_16x16x32_bf16 v[108:111], v[204:207], v[184:187], v[108:111]
ds_read_b64_tr_b16 v[208:209], v240 offset:16384
v_mfma_f32_16x16x32_bf16 v[92:95], v[204:207], v[140:143], v[92:95]
ds_read_b64_tr_b16 v[210:211], v240 offset:17408
v_mfma_f32_16x16x32_bf16 v[92:95], v[188:191], v[184:187], v[92:95]
ds_read_b128 v[248:251], v236 offset:33280
v_mfma_f32_16x16x32_bf16 v[92:95], v[200:203], v[180:183], v[92:95]
ds_read_b128 v[216:219], v236 offset:33536
v_mfma_f32_16x16x32_bf16 v[76:79], v[200:203], v[184:187], v[76:79]
ds_read_b128 v[224:227], v236 offset:33792
v_mfma_f32_16x16x32_bf16 v[76:79], v[188:191], v[140:143], v[76:79]
ds_read_b128 v[132:135], v236 offset:34048
v_mfma_f32_16x16x32_bf16 v[76:79], v[204:207], v[144:147], v[76:79]
ds_read_b128 v[148:151], v236 offset:34304
v_mfma_f32_16x16x32_bf16 v[60:63], v[204:207], v[164:167], v[60:63]
ds_read_b128 v[172:175], v236 offset:34560
v_mfma_f32_16x16x32_bf16 v[60:63], v[188:191], v[144:147], v[60:63]
ds_read_b128 v[192:195], v237 offset:32768
v_mfma_f32_16x16x32_bf16 v[60:63], v[200:203], v[140:143], v[60:63]
ds_read_b128 v[156:159], v237 offset:33024
v_mfma_f32_16x16x32_bf16 v[44:47], v[200:203], v[144:147], v[44:47]
ds_read_b64_tr_b16 v[176:177], v242 offset:12288
v_mfma_f32_16x16x32_bf16 v[44:47], v[188:191], v[164:167], v[44:47]
ds_read_b64_tr_b16 v[178:179], v242 offset:13312
v_mfma_f32_16x16x32_bf16 v[44:47], v[204:207], v[136:139], v[44:47]
ds_read_b64_tr_b16 v[196:197], v242 offset:14336
v_mfma_f32_16x16x32_bf16 v[28:31], v[204:207], v[228:231], v[28:31]
ds_read_b64_tr_b16 v[198:199], v242 offset:15360
v_mfma_f32_16x16x32_bf16 v[28:31], v[188:191], v[136:139], v[28:31]
ds_read_b64_tr_b16 v[128:129], v242 offset:16384
v_mfma_f32_16x16x32_bf16 v[28:31], v[200:203], v[164:167], v[28:31]
ds_read_b64_tr_b16 v[130:131], v242 offset:17408
v_mfma_f32_16x16x32_bf16 v[12:15], v[200:203], v[136:139], v[12:15]
v_mfma_f32_16x16x32_bf16 v[12:15], v[188:191], v[228:231], v[12:15]
v_mfma_f32_16x16x32_bf16 v[12:15], v[204:207], v[220:223], v[12:15]
s_waitcnt lgkmcnt(14)
v_mfma_f32_16x16x32_bf16 v[0:3], v[232:235], v[168:171], v[0:3]
ds_read_b64_tr_b16 v[160:161], v241 offset:12288
v_mfma_f32_16x16x32_bf16 v[0:3], v[152:155], v[212:215], v[0:3]
s_waitcnt lgkmcnt(14)
ds_read_b64_tr_b16 v[162:163], v241 offset:13312
v_mfma_f32_16x16x32_bf16 v[0:3], v[208:211], v[248:251], v[0:3]
s_waitcnt lgkmcnt(14)
ds_read_b64_tr_b16 v[180:181], v241 offset:14336
v_mfma_f32_16x16x32_bf16 v[16:19], v[208:211], v[216:219], v[16:19]
ds_read_b64_tr_b16 v[182:183], v241 offset:15360
v_mfma_f32_16x16x32_bf16 v[16:19], v[152:155], v[248:251], v[16:19]
ds_read_b64_tr_b16 v[184:185], v241 offset:16384
v_mfma_f32_16x16x32_bf16 v[16:19], v[232:235], v[212:215], v[16:19]
ds_read_b64_tr_b16 v[186:187], v241 offset:17408
v_mfma_f32_16x16x32_bf16 v[32:35], v[232:235], v[248:251], v[32:35]
v_mfma_f32_16x16x32_bf16 v[32:35], v[152:155], v[216:219], v[32:35]
s_waitcnt lgkmcnt(14)
v_mfma_f32_16x16x32_bf16 v[32:35], v[208:211], v[224:227], v[32:35]
v_mfma_f32_16x16x32_bf16 v[48:51], v[208:211], v[132:135], v[48:51]
v_mfma_f32_16x16x32_bf16 v[48:51], v[152:155], v[224:227], v[48:51]
v_mfma_f32_16x16x32_bf16 v[48:51], v[232:235], v[216:219], v[48:51]
v_mfma_f32_16x16x32_bf16 v[64:67], v[232:235], v[224:227], v[64:67]
v_mfma_f32_16x16x32_bf16 v[64:67], v[152:155], v[132:135], v[64:67]
v_mfma_f32_16x16x32_bf16 v[64:67], v[208:211], v[148:151], v[64:67]
v_mfma_f32_16x16x32_bf16 v[80:83], v[208:211], v[172:175], v[80:83]
v_mfma_f32_16x16x32_bf16 v[80:83], v[152:155], v[148:151], v[80:83]
v_mfma_f32_16x16x32_bf16 v[80:83], v[232:235], v[132:135], v[80:83]
v_mfma_f32_16x16x32_bf16 v[96:99], v[232:235], v[148:151], v[96:99]
v_mfma_f32_16x16x32_bf16 v[96:99], v[152:155], v[172:175], v[96:99]
s_waitcnt lgkmcnt(13)
v_mfma_f32_16x16x32_bf16 v[96:99], v[208:211], v[192:195], v[96:99]
s_waitcnt lgkmcnt(12)
v_mfma_f32_16x16x32_bf16 v[112:115], v[208:211], v[156:159], v[112:115]
v_mfma_f32_16x16x32_bf16 v[112:115], v[152:155], v[192:195], v[112:115]
v_mfma_f32_16x16x32_bf16 v[112:115], v[232:235], v[172:175], v[112:115]
s_waitcnt lgkmcnt(10)
v_mfma_f32_16x16x32_bf16 v[120:123], v[176:179], v[172:175], v[120:123]
s_waitcnt lgkmcnt(8)
ds_read_b64_tr_b16 v[140:141], v243 offset:12288
v_mfma_f32_16x16x32_bf16 v[120:123], v[196:199], v[192:195], v[120:123]
s_waitcnt lgkmcnt(7)
ds_read_b64_tr_b16 v[142:143], v243 offset:13312
v_mfma_f32_16x16x32_bf16 v[120:123], v[128:131], v[156:159], v[120:123]
ds_read_b64_tr_b16 v[144:145], v243 offset:14336
v_mfma_f32_16x16x32_bf16 v[104:107], v[128:131], v[192:195], v[104:107]
ds_read_b64_tr_b16 v[146:147], v243 offset:15360
v_mfma_f32_16x16x32_bf16 v[104:107], v[196:199], v[172:175], v[104:107]
ds_read_b64_tr_b16 v[164:165], v243 offset:16384
v_mfma_f32_16x16x32_bf16 v[104:107], v[176:179], v[148:151], v[104:107]
ds_read_b64_tr_b16 v[166:167], v243 offset:17408
v_mfma_f32_16x16x32_bf16 v[88:91], v[176:179], v[132:135], v[88:91]
v_mfma_f32_16x16x32_bf16 v[88:91], v[196:199], v[148:151], v[88:91]
v_mfma_f32_16x16x32_bf16 v[88:91], v[128:131], v[172:175], v[88:91]
v_mfma_f32_16x16x32_bf16 v[72:75], v[128:131], v[148:151], v[72:75]
v_mfma_f32_16x16x32_bf16 v[72:75], v[196:199], v[132:135], v[72:75]
v_mfma_f32_16x16x32_bf16 v[72:75], v[176:179], v[224:227], v[72:75]
v_mfma_f32_16x16x32_bf16 v[56:59], v[176:179], v[216:219], v[56:59]
v_mfma_f32_16x16x32_bf16 v[56:59], v[196:199], v[224:227], v[56:59]
v_mfma_f32_16x16x32_bf16 v[56:59], v[128:131], v[132:135], v[56:59]
v_mfma_f32_16x16x32_bf16 v[40:43], v[128:131], v[224:227], v[40:43]
v_mfma_f32_16x16x32_bf16 v[40:43], v[196:199], v[216:219], v[40:43]
v_mfma_f32_16x16x32_bf16 v[40:43], v[176:179], v[248:251], v[40:43]
v_mfma_f32_16x16x32_bf16 v[24:27], v[176:179], v[212:215], v[24:27]
v_mfma_f32_16x16x32_bf16 v[24:27], v[196:199], v[248:251], v[24:27]
v_mfma_f32_16x16x32_bf16 v[24:27], v[128:131], v[216:219], v[24:27]
v_mfma_f32_16x16x32_bf16 v[8:11], v[128:131], v[248:251], v[8:11]
v_mfma_f32_16x16x32_bf16 v[8:11], v[196:199], v[212:215], v[8:11]
v_mfma_f32_16x16x32_bf16 v[8:11], v[176:179], v[168:171], v[8:11]
s_waitcnt lgkmcnt(10)
v_mfma_f32_16x16x32_bf16 v[4:7], v[160:163], v[168:171], v[4:7]
s_waitcnt lgkmcnt(8)
v_mfma_f32_16x16x32_bf16 v[4:7], v[180:183], v[212:215], v[4:7]
s_waitcnt lgkmcnt(6)
v_mfma_f32_16x16x32_bf16 v[4:7], v[184:187], v[248:251], v[4:7]
v_mfma_f32_16x16x32_bf16 v[20:23], v[184:187], v[216:219], v[20:23]
v_mfma_f32_16x16x32_bf16 v[20:23], v[180:183], v[248:251], v[20:23]
v_mfma_f32_16x16x32_bf16 v[20:23], v[160:163], v[212:215], v[20:23]
v_mfma_f32_16x16x32_bf16 v[36:39], v[160:163], v[248:251], v[36:39]
v_mfma_f32_16x16x32_bf16 v[36:39], v[180:183], v[216:219], v[36:39]
v_mfma_f32_16x16x32_bf16 v[36:39], v[184:187], v[224:227], v[36:39]
v_mfma_f32_16x16x32_bf16 v[52:55], v[184:187], v[132:135], v[52:55]
v_mfma_f32_16x16x32_bf16 v[52:55], v[180:183], v[224:227], v[52:55]
v_mfma_f32_16x16x32_bf16 v[52:55], v[160:163], v[216:219], v[52:55]
v_mfma_f32_16x16x32_bf16 v[68:71], v[160:163], v[224:227], v[68:71]
v_mfma_f32_16x16x32_bf16 v[68:71], v[180:183], v[132:135], v[68:71]
v_mfma_f32_16x16x32_bf16 v[68:71], v[184:187], v[148:151], v[68:71]
v_mfma_f32_16x16x32_bf16 v[84:87], v[184:187], v[172:175], v[84:87]
v_mfma_f32_16x16x32_bf16 v[84:87], v[180:183], v[148:151], v[84:87]
v_mfma_f32_16x16x32_bf16 v[84:87], v[160:163], v[132:135], v[84:87]
v_mfma_f32_16x16x32_bf16 v[100:103], v[160:163], v[148:151], v[100:103]
L_pad2:
s_cmp_eq_u32 s79, 1
s_cbranch_scc1 L_lret2
v_mfma_f32_16x16x32_bf16 v[100:103], v[180:183], v[172:175], v[100:103]
v_mfma_f32_16x16x32_bf16 v[100:103], v[184:187], v[192:195], v[100:103]
v_mfma_f32_16x16x32_bf16 v[116:119], v[184:187], v[156:159], v[116:119]
v_mfma_f32_16x16x32_bf16 v[116:119], v[180:183], v[192:195], v[116:119]
v_mfma_f32_16x16x32_bf16 v[116:119], v[160:163], v[172:175], v[116:119]
s_waitcnt lgkmcnt(4)
s_waitcnt lgkmcnt(0)
s_barrier
v_mfma_f32_16x16x32_bf16 v[124:127], v[140:143], v[172:175], v[124:127]
ds_read_b64_tr_b16 v[200:201], v240 offset:18432
v_mfma_f32_16x16x32_bf16 v[124:127], v[144:147], v[192:195], v[124:127]
ds_read_b64_tr_b16 v[202:203], v240 offset:19456
v_mfma_f32_16x16x32_bf16 v[124:127], v[164:167], v[156:159], v[124:127]
ds_read_b128 v[136:139], v238 offset:32768
v_mfma_f32_16x16x32_bf16 v[108:111], v[164:167], v[192:195], v[108:111]
ds_read_b64_tr_b16 v[188:189], v240 offset:20480
v_mfma_f32_16x16x32_bf16 v[108:111], v[144:147], v[172:175], v[108:111]
ds_read_b64_tr_b16 v[190:191], v240 offset:21504
v_mfma_f32_16x16x32_bf16 v[108:111], v[140:143], v[148:151], v[108:111]
ds_read_b128 v[228:231], v238 offset:33024
v_mfma_f32_16x16x32_bf16 v[92:95], v[140:143], v[132:135], v[92:95]
ds_read_b64_tr_b16 v[204:205], v240 offset:22528
v_mfma_f32_16x16x32_bf16 v[92:95], v[144:147], v[148:151], v[92:95]
ds_read_b64_tr_b16 v[206:207], v240 offset:23552
v_mfma_f32_16x16x32_bf16 v[92:95], v[164:167], v[172:175], v[92:95]
ds_read_b128 v[220:223], v238 offset:33280
v_mfma_f32_16x16x32_bf16 v[76:79], v[164:167], v[148:151], v[76:79]
ds_read_b128 v[208:211], v238 offset:33536
v_mfma_f32_16x16x32_bf16 v[76:79], v[144:147], v[132:135], v[76:79]
ds_read_b128 v[152:155], v238 offset:33792
v_mfma_f32_16x16x32_bf16 v[76:79], v[140:143], v[224:227], v[76:79]
ds_read_b128 v[232:235], v238 offset:34048
v_mfma_f32_16x16x32_bf16 v[60:63], v[140:143], v[216:219], v[60:63]
ds_read_b128 v[128:131], v238 offset:34304
v_mfma_f32_16x16x32_bf16 v[60:63], v[144:147], v[224:227], v[60:63]
ds_read_b128 v[196:199], v238 offset:34560
v_mfma_f32_16x16x32_bf16 v[60:63], v[164:167], v[132:135], v[60:63]
ds_read_b128 v[176:179], v239 offset:32768
v_mfma_f32_16x16x32_bf16 v[44:47], v[164:167], v[224:227], v[44:47]
ds_read_b128 v[184:187], v239 offset:33024
v_mfma_f32_16x16x32_bf16 v[44:47], v[144:147], v[216:219], v[44:47]
ds_read_b64_tr_b16 v[180:181], v242 offset:18432
v_mfma_f32_16x16x32_bf16 v[44:47], v[140:143], v[248:251], v[44:47]
ds_read_b64_tr_b16 v[182:183], v242 offset:19456
v_mfma_f32_16x16x32_bf16 v[28:31], v[140:143], v[212:215], v[28:31]
ds_read_b64_tr_b16 v[160:161], v242 offset:20480
v_mfma_f32_16x16x32_bf16 v[28:31], v[144:147], v[248:251], v[28:31]
ds_read_b64_tr_b16 v[162:163], v242 offset:21504
v_mfma_f32_16x16x32_bf16 v[28:31], v[164:167], v[216:219], v[28:31]
ds_read_b64_tr_b16 v[156:157], v242 offset:22528
v_mfma_f32_16x16x32_bf16 v[12:15], v[164:167], v[248:251], v[12:15]
ds_read_b64_tr_b16 v[158:159], v242 offset:23552
v_mfma_f32_16x16x32_bf16 v[12:15], v[144:147], v[212:215], v[12:15]
v_mfma_f32_16x16x32_bf16 v[12:15], v[140:143], v[168:171], v[12:15]
s_waitcnt lgkmcnt(14)
v_mfma_f32_16x16x32_bf16 v[0:3], v[200:203], v[136:139], v[0:3]
ds_read_b64_tr_b16 v[192:193], v241 offset:18432
v_mfma_f32_16x16x32_bf16 v[0:3], v[188:191], v[228:231], v[0:3]
s_waitcnt lgkmcnt(14)
ds_read_b64_tr_b16 v[194:195], v241 offset:19456
v_mfma_f32_16x16x32_bf16 v[0:3], v[204:207], v[220:223], v[0:3]
s_waitcnt lgkmcnt(14)
ds_read_b64_tr_b16 v[172:173], v241 offset:20480
v_mfma_f32_16x16x32_bf16 v[16:19], v[204:207], v[208:211], v[16:19]
ds_read_b64_tr_b16 v[174:175], v241 offset:21504
v_mfma_f32_16x16x32_bf16 v[16:19], v[188:191], v[220:223], v[16:19]
ds_read_b64_tr_b16 v[148:149], v241 offset:22528
v_mfma_f32_16x16x32_bf16 v[16:19], v[200:203], v[228:231], v[16:19]
ds_read_b64_tr_b16 v[150:151], v241 offset:23552
v_mfma_f32_16x16x32_bf16 v[32:35], v[200:203], v[220:223], v[32:35]
v_mfma_f32_16x16x32_bf16 v[32:35], v[188:191], v[208:211], v[32:35]
s_waitcnt lgkmcnt(14)
v_mfma_f32_16x16x32_bf16 v[32:35], v[204:207], v[152:155], v[32:35]
v_mfma_f32_16x16x32_bf16 v[48:51], v[204:207], v[232:235], v[48:51]
v_mfma_f32_16x16x32_bf16 v[48:51], v[188:191], v[152:155], v[48:51]
v_mfma_f32_16x16x32_bf16 v[48:51], v[200:203], v[208:211], v[48:51]
v_mfma_f32_16x16x32_bf16 v[64:67], v[200:203], v[152:155], v[64:67]
v_mfma_f32_16x16x32_bf16 v[64:67], v[188:191], v[232:235], v[64:67]
v_mfma_f32_16x16x32_bf16 v[64:67], v[204:207], v[128:131], v[64:67]
v_mfma_f32_16x16x32_bf16 v[80:83], v[204:207], v[196:199], v[80:83]
v_mfma_f32_16x16x32_bf16 v[80:83], v[188:191], v[128:131], v[80:83]
v_mfma_f32_16x16x32_bf16 v[80:83], v[200:203], v[232:235], v[80:83]
v_mfma_f32_16x16x32_bf16 v[96:99], v[200:203], v[128:131], v[96:99]
v_mfma_f32_16x16x32_bf16 v[96:99], v[188:191], v[196:199], v[96:99]
s_waitcnt lgkmcnt(13)
v_mfma_f32_16x16x32_bf16 v[96:99], v[204:207], v[176:179], v[96:99]
s_waitcnt lgkmcnt(12)
v_mfma_f32_16x16x32_bf16 v[112:115], v[204:207], v[184:187], v[112:115]
v_mfma_f32_16x16x32_bf16 v[112:115], v[188:191], v[176:179], v[112:115]
v_mfma_f32_16x16x32_bf16 v[112:115], v[200:203], v[196:199], v[112:115]
s_waitcnt lgkmcnt(10)
v_mfma_f32_16x16x32_bf16 v[120:123], v[180:183], v[196:199], v[120:123]
s_waitcnt lgkmcnt(8)
ds_read_b64_tr_b16 v[132:133], v243 offset:18432
v_mfma_f32_16x16x32_bf16 v[120:123], v[160:163], v[176:179], v[120:123]
s_waitcnt lgkmcnt(7)
ds_read_b64_tr_b16 v[134:135], v243 offset:19456
v_mfma_f32_16x16x32_bf16 v[120:123], v[156:159], v[184:187], v[120:123]
ds_read_b64_tr_b16 v[224:225], v243 offset:20480
v_mfma_f32_16x16x32_bf16 v[104:107], v[156:159], v[176:179], v[104:107]
ds_read_b64_tr_b16 v[226:227], v243 offset:21504
v_mfma_f32_16x16x32_bf16 v[104:107], v[160:163], v[196:199], v[104:107]
ds_read_b64_tr_b16 v[216:217], v243 offset:22528
v_mfma_f32_16x16x32_bf16 v[104:107], v[180:183], v[128:131], v[104:107]
ds_read_b64_tr_b16 v[218:219], v243 offset:23552
v_mfma_f32_16x16x32_bf16 v[88:91], v[180:183], v[232:235], v[88:91]
v_mfma_f32_16x16x32_bf16 v[88:91], v[160:163], v[128:131], v[88:91]
v_mfma_f32_16x16x32_bf16 v[88:91], v[156:159], v[196:199], v[88:91]
v_mfma_f32_16x16x32_bf16 v[72:75], v[156:159], v[128:131], v[72:75]
v_mfma_f32_16x16x32_bf16 v[72:75], v[160:163], v[232:235], v[72:75]
v_mfma_f32_16x16x32_bf16 v[72:75], v[180:183], v[152:155], v[72:75]
v_mfma_f32_16x16x32_bf16 v[56:59], v[180:183], v[208:211], v[56:59]
v_mfma_f32_16x16x32_bf16 v[56:59], v[160:163], v[152:155], v[56:59]
v_mfma_f32_16x16x32_bf16 v[56:59], v[156:159], v[232:235], v[56:59]
v_mfma_f32_16x16x32_bf16 v[40:43], v[156:159], v[152:155], v[40:43]
v_mfma_f32_16x16x32_bf16 v[40:43], v[160:163], v[208:211], v[40:43]
v_mfma_f32_16x16x32_bf16 v[40:43], v[180:183], v[220:223], v[40:43]
v_mfma_f32_16x16x32_bf16 v[24:27], v[180:183], v[228:231], v[24:27]
v_mfma_f32_16x16x32_bf16 v[24:27], v[160:163], v[220:223], v[24:27]
v_mfma_f32_16x16x32_bf16 v[24:27], v[156:159], v[208:211], v[24:27]
v_mfma_f32_16x16x32_bf16 v[8:11], v[156:159], v[220:223], v[8:11]
v_mfma_f32_16x16x32_bf16 v[8:11], v[160:163], v[228:231], v[8:11]
v_mfma_f32_16x16x32_bf16 v[8:11], v[180:183], v[136:139], v[8:11]
s_waitcnt lgkmcnt(10)
v_mfma_f32_16x16x32_bf16 v[4:7], v[192:195], v[136:139], v[4:7]
s_waitcnt lgkmcnt(8)
v_mfma_f32_16x16x32_bf16 v[4:7], v[172:175], v[228:231], v[4:7]
s_waitcnt lgkmcnt(6)
v_mfma_f32_16x16x32_bf16 v[4:7], v[148:151], v[220:223], v[4:7]
v_mfma_f32_16x16x32_bf16 v[20:23], v[148:151], v[208:211], v[20:23]
v_mfma_f32_16x16x32_bf16 v[20:23], v[172:175], v[220:223], v[20:23]
v_mfma_f32_16x16x32_bf16 v[20:23], v[192:195], v[228:231], v[20:23]
v_mfma_f32_16x16x32_bf16 v[36:39], v[192:195], v[220:223], v[36:39]
v_mfma_f32_16x16x32_bf16 v[36:39], v[172:175], v[208:211], v[36:39]
v_mfma_f32_16x16x32_bf16 v[36:39], v[148:151], v[152:155], v[36:39]
v_mfma_f32_16x16x32_bf16 v[52:55], v[148:151], v[232:235], v[52:55]
v_mfma_f32_16x16x32_bf16 v[52:55], v[172:175], v[152:155], v[52:55]
v_mfma_f32_16x16x32_bf16 v[52:55], v[192:195], v[208:211], v[52:55]
v_mfma_f32_16x16x32_bf16 v[68:71], v[192:195], v[152:155], v[68:71]
v_mfma_f32_16x16x32_bf16 v[68:71], v[172:175], v[232:235], v[68:71]
v_mfma_f32_16x16x32_bf16 v[68:71], v[148:151], v[128:131], v[68:71]
v_mfma_f32_16x16x32_bf16 v[84:87], v[148:151], v[196:199], v[84:87]
v_mfma_f32_16x16x32_bf16 v[84:87], v[172:175], v[128:131], v[84:87]
v_mfma_f32_16x16x32_bf16 v[84:87], v[192:195], v[232:235], v[84:87]
v_mfma_f32_16x16x32_bf16 v[100:103], v[192:195], v[128:131], v[100:103]
v_mfma_f32_16x16x32_bf16 v[100:103], v[172:175], v[196:199], v[100:103]
v_mfma_f32_16x16x32_bf16 v[100:103], v[148:151], v[176:179], v[100:103]
v_mfma_f32_16x16x32_bf16 v[116:119], v[148:151], v[184:187], v[116:119]
v_mfma_f32_16x16x32_bf16 v[116:119], v[172:175], v[176:179], v[116:119]
v_mfma_f32_16x16x32_bf16 v[116:119], v[192:195], v[196:199], v[116:119]
s_waitcnt lgkmcnt(4)
s_waitcnt lgkmcnt(2)
s_barrier
v_mfma_f32_16x16x32_bf16 v[124:127], v[132:135], v[196:199], v[124:127]
ds_read_b64_tr_b16 v[164:165], v240 offset:0
v_mfma_f32_16x16x32_bf16 v[124:127], v[224:227], v[176:179], v[124:127]
s_waitcnt lgkmcnt(1)
ds_read_b64_tr_b16 v[166:167], v240 offset:1024
v_mfma_f32_16x16x32_bf16 v[124:127], v[216:219], v[184:187], v[124:127]
ds_read_b128 v[248:251], v236 offset:0
v_mfma_f32_16x16x32_bf16 v[108:111], v[216:219], v[176:179], v[108:111]
ds_read_b64_tr_b16 v[144:145], v240 offset:2048
v_mfma_f32_16x16x32_bf16 v[108:111], v[224:227], v[196:199], v[108:111]
ds_read_b64_tr_b16 v[146:147], v240 offset:3072
v_mfma_f32_16x16x32_bf16 v[108:111], v[132:135], v[128:131], v[108:111]
ds_read_b128 v[212:215], v236 offset:256
v_mfma_f32_16x16x32_bf16 v[92:95], v[132:135], v[232:235], v[92:95]
ds_read_b64_tr_b16 v[140:141], v240 offset:4096
v_mfma_f32_16x16x32_bf16 v[92:95], v[224:227], v[128:131], v[92:95]
ds_read_b64_tr_b16 v[142:143], v240 offset:5120
v_mfma_f32_16x16x32_bf16 v[92:95], v[216:219], v[196:199], v[92:95]
ds_read_b128 v[168:171], v236 offset:512
v_mfma_f32_16x16x32_bf16 v[76:79], v[216:219], v[128:131], v[76:79]
ds_read_b128 v[204:207], v236 offset:768
v_mfma_f32_16x16x32_bf16 v[76:79], v[224:227], v[232:235], v[76:79]
ds_read_b128 v[188:191], v236 offset:1024
v_mfma_f32_16x16x32_bf16 v[76:79], v[132:135], v[152:155], v[76:79]
ds_read_b128 v[200:203], v236 offset:1280
v_mfma_f32_16x16x32_bf16 v[60:63], v[132:135], v[208:211], v[60:63]
ds_read_b128 v[156:159], v236 offset:1536
v_mfma_f32_16x16x32_bf16 v[60:63], v[224:227], v[152:155], v[60:63]
ds_read_b128 v[160:163], v236 offset:1792
v_mfma_f32_16x16x32_bf16 v[60:63], v[216:219], v[232:235], v[60:63]
ds_read_b128 v[180:183], v237 offset:0
v_mfma_f32_16x16x32_bf16 v[44:47], v[216:219], v[152:155], v[44:47]
ds_read_b128 v[148:151], v237 offset:256
v_mfma_f32_16x16x32_bf16 v[44:47], v[224:227], v[208:211], v[44:47]
ds_read_b64_tr_b16 v[172:173], v242 offset:0
v_mfma_f32_16x16x32_bf16 v[44:47], v[132:135], v[220:223], v[44:47]
ds_read_b64_tr_b16 v[174:175], v242 offset:1024
v_mfma_f32_16x16x32_bf16 v[28:31], v[132:135], v[228:231], v[28:31]
ds_read_b64_tr_b16 v[192:193], v242 offset:2048
v_mfma_f32_16x16x32_bf16 v[28:31], v[224:227], v[220:223], v[28:31]
ds_read_b64_tr_b16 v[194:195], v242 offset:3072
v_mfma_f32_16x16x32_bf16 v[28:31], v[216:219], v[208:211], v[28:31]
ds_read_b64_tr_b16 v[184:185], v242 offset:4096
v_mfma_f32_16x16x32_bf16 v[12:15], v[216:219], v[220:223], v[12:15]
ds_read_b64_tr_b16 v[186:187], v242 offset:5120
v_mfma_f32_16x16x32_bf16 v[12:15], v[224:227], v[228:231], v[12:15]
v_mfma_f32_16x16x32_bf16 v[12:15], v[132:135], v[136:139], v[12:15]
s_waitcnt lgkmcnt(14)
v_mfma_f32_16x16x32_bf16 v[0:3], v[164:167], v[248:251], v[0:3]
ds_read_b64_tr_b16 v[176:177], v241 offset:0
v_mfma_f32_16x16x32_bf16 v[0:3], v[144:147], v[212:215], v[0:3]
s_waitcnt lgkmcnt(14)
ds_read_b64_tr_b16 v[178:179], v241 offset:1024
v_mfma_f32_16x16x32_bf16 v[0:3], v[140:143], v[168:171], v[0:3]
s_waitcnt lgkmcnt(14)
ds_read_b64_tr_b16 v[196:197], v241 offset:2048
v_mfma_f32_16x16x32_bf16 v[16:19], v[140:143], v[204:207], v[16:19]
ds_read_b64_tr_b16 v[198:199], v241 offset:3072
v_mfma_f32_16x16x32_bf16 v[16:19], v[144:147], v[168:171], v[16:19]
ds_read_b64_tr_b16 v[128:129], v241 offset:4096
v_mfma_f32_16x16x32_bf16 v[16:19], v[164:167], v[212:215], v[16:19]
ds_read_b64_tr_b16 v[130:131], v241 offset:5120
v_mfma_f32_16x16x32_bf16 v[32:35], v[164:167], v[168:171], v[32:35]
v_mfma_f32_16x16x32_bf16 v[32:35], v[144:147], v[204:207], v[32:35]
s_waitcnt lgkmcnt(14)
v_mfma_f32_16x16x32_bf16 v[32:35], v[140:143], v[188:191], v[32:35]
v_mfma_f32_16x16x32_bf16 v[48:51], v[140:143], v[200:203], v[48:51]
v_mfma_f32_16x16x32_bf16 v[48:51], v[144:147], v[188:191], v[48:51]
v_mfma_f32_16x16x32_bf16 v[48:51], v[164:167], v[204:207], v[48:51]
v_mfma_f32_16x16x32_bf16 v[64:67], v[164:167], v[188:191], v[64:67]
v_mfma_f32_16x16x32_bf16 v[64:67], v[144:147], v[200:203], v[64:67]
v_mfma_f32_16x16x32_bf16 v[64:67], v[140:143], v[156:159], v[64:67]
v_mfma_f32_16x16x32_bf16 v[80:83], v[140:143], v[160:163], v[80:83]
v_mfma_f32_16x16x32_bf16 v[80:83], v[144:147], v[156:159], v[80:83]
v_mfma_f32_16x16x32_bf16 v[80:83], v[164:167], v[200:203], v[80:83]
v_mfma_f32_16x16x32_bf16 v[96:99], v[164:167], v[156:159], v[96:99]
v_mfma_f32_16x16x32_bf16 v[96:99], v[144:147], v[160:163], v[96:99]
s_waitcnt lgkmcnt(13)
v_mfma_f32_16x16x32_bf16 v[96:99], v[140:143], v[180:183], v[96:99]
s_waitcnt lgkmcnt(12)
v_mfma_f32_16x16x32_bf16 v[112:115], v[140:143], v[148:151], v[112:115]
v_mfma_f32_16x16x32_bf16 v[112:115], v[144:147], v[180:183], v[112:115]
v_mfma_f32_16x16x32_bf16 v[112:115], v[164:167], v[160:163], v[112:115]
s_waitcnt lgkmcnt(10)
v_mfma_f32_16x16x32_bf16 v[120:123], v[172:175], v[160:163], v[120:123]
s_waitcnt lgkmcnt(8)
ds_read_b64_tr_b16 v[232:233], v243 offset:0
v_mfma_f32_16x16x32_bf16 v[120:123], v[192:195], v[180:183], v[120:123]
s_waitcnt lgkmcnt(7)
ds_read_b64_tr_b16 v[234:235], v243 offset:1024
v_mfma_f32_16x16x32_bf16 v[120:123], v[184:187], v[148:151], v[120:123]
ds_read_b64_tr_b16 v[152:153], v243 offset:2048
v_mfma_f32_16x16x32_bf16 v[104:107], v[184:187], v[180:183], v[104:107]
ds_read_b64_tr_b16 v[154:155], v243 offset:3072
v_mfma_f32_16x16x32_bf16 v[104:107], v[192:195], v[160:163], v[104:107]
ds_read_b64_tr_b16 v[208:209], v243 offset:4096
v_mfma_f32_16x16x32_bf16 v[104:107], v[172:175], v[156:159], v[104:107]
ds_read_b64_tr_b16 v[210:211], v243 offset:5120
v_mfma_f32_16x16x32_bf16 v[88:91], v[172:175], v[200:203], v[88:91]
v_mfma_f32_16x16x32_bf16 v[88:91], v[192:195], v[156:159], v[88:91]
v_mfma_f32_16x16x32_bf16 v[88:91], v[184:187], v[160:163], v[88:91]
v_mfma_f32_16x16x32_bf16 v[72:75], v[184:187], v[156:159], v[72:75]
v_mfma_f32_16x16x32_bf16 v[72:75], v[192:195], v[200:203], v[72:75]
v_mfma_f32_16x16x32_bf16 v[72:75], v[172:175], v[188:191], v[72:75]
v_mfma_f32_16x16x32_bf16 v[56:59], v[172:175], v[204:207], v[56:59]
v_mfma_f32_16x16x32_bf16 v[56:59], v[192:195], v[188:191], v[56:59]
v_mfma_f32_16x16x32_bf16 v[56:59], v[184:187], v[200:203], v[56:59]
v_mfma_f32_16x16x32_bf16 v[40:43], v[184:187], v[188:191], v[40:43]
v_mfma_f32_16x16x32_bf16 v[40:43], v[192:195], v[204:207], v[40:43]
v_mfma_f32_16x16x32_bf16 v[40:43], v[172:175], v[168:171], v[40:43]
v_mfma_f32_16x16x32_bf16 v[24:27], v[172:175], v[212:215], v[24:27]
v_mfma_f32_16x16x32_bf16 v[24:27], v[192:195], v[168:171], v[24:27]
v_mfma_f32_16x16x32_bf16 v[24:27], v[184:187], v[204:207], v[24:27]
v_mfma_f32_16x16x32_bf16 v[8:11], v[184:187], v[168:171], v[8:11]
v_mfma_f32_16x16x32_bf16 v[8:11], v[192:195], v[212:215], v[8:11]
v_mfma_f32_16x16x32_bf16 v[8:11], v[172:175], v[248:251], v[8:11]
s_waitcnt lgkmcnt(10)
v_mfma_f32_16x16x32_bf16 v[4:7], v[176:179], v[248:251], v[4:7]
s_waitcnt lgkmcnt(8)
v_mfma_f32_16x16x32_bf16 v[4:7], v[196:199], v[212:215], v[4:7]
s_waitcnt lgkmcnt(6)
v_mfma_f32_16x16x32_bf16 v[4:7], v[128:131], v[168:171], v[4:7]
v_mfma_f32_16x16x32_bf16 v[20:23], v[128:131], v[204:207], v[20:23]
v_mfma_f32_16x16x32_bf16 v[20:23], v[196:199], v[168:171], v[20:23]
v_mfma_f32_16x16x32_bf16 v[20:23], v[176:179], v[212:215], v[20:23]
v_mfma_f32_16x16x32_bf16 v[36:39], v[176:179], v[168:171], v[36:39]
v_mfma_f32_16x16x32_bf16 v[36:39], v[196:199], v[204:207], v[36:39]
v_mfma_f32_16x16x32_bf16 v[36:39], v[128:131], v[188:191], v[36:39]
v_mfma_f32_16x16x32_bf16 v[52:55], v[128:131], v[200:203], v[52:55]
v_mfma_f32_16x16x32_bf16 v[52:55], v[196:199], v[188:191], v[52:55]
v_mfma_f32_16x16x32_bf16 v[52:55], v[176:179], v[204:207], v[52:55]
v_mfma_f32_16x16x32_bf16 v[68:71], v[176:179], v[188:191], v[68:71]
v_mfma_f32_16x16x32_bf16 v[68:71], v[196:199], v[200:203], v[68:71]
v_mfma_f32_16x16x32_bf16 v[68:71], v[128:131], v[156:159], v[68:71]
v_mfma_f32_16x16x32_bf16 v[84:87], v[128:131], v[160:163], v[84:87]
v_mfma_f32_16x16x32_bf16 v[84:87], v[196:199], v[156:159], v[84:87]
v_mfma_f32_16x16x32_bf16 v[84:87], v[176:179], v[200:203], v[84:87]
v_mfma_f32_16x16x32_bf16 v[100:103], v[176:179], v[156:159], v[100:103]
v_mfma_f32_16x16x32_bf16 v[100:103], v[196:199], v[160:163], v[100:103]
v_mfma_f32_16x16x32_bf16 v[100:103], v[128:131], v[180:183], v[100:103]
v_mfma_f32_16x16x32_bf16 v[116:119], v[128:131], v[148:151], v[116:119]
v_mfma_f32_16x16x32_bf16 v[116:119], v[196:199], v[180:183], v[116:119]
v_mfma_f32_16x16x32_bf16 v[116:119], v[176:179], v[160:163], v[116:119]
s_waitcnt lgkmcnt(4)
s_waitcnt lgkmcnt(0)
s_barrier
v_mfma_f32_16x16x32_bf16 v[124:127], v[232:235], v[160:163], v[124:127]
ds_read_b64_tr_b16 v[216:217], v240 offset:6144
v_mfma_f32_16x16x32_bf16 v[124:127], v[152:155], v[180:183], v[124:127]
ds_read_b64_tr_b16 v[218:219], v240 offset:7168
v_mfma_f32_16x16x32_bf16 v[124:127], v[208:211], v[148:151], v[124:127]
ds_read_b128 v[220:223], v238 offset:0
v_mfma_f32_16x16x32_bf16 v[108:111], v[208:211], v[180:183], v[108:111]
ds_read_b64_tr_b16 v[224:225], v240 offset:8192
v_mfma_f32_16x16x32_bf16 v[108:111], v[152:155], v[160:163], v[108:111]
ds_read_b64_tr_b16 v[226:227], v240 offset:9216
v_mfma_f32_16x16x32_bf16 v[108:111], v[232:235], v[156:159], v[108:111]
ds_read_b128 v[228:231], v238 offset:256
v_mfma_f32_16x16x32_bf16 v[92:95], v[232:235], v[200:203], v[92:95]
ds_read_b64_tr_b16 v[132:133], v240 offset:10240
v_mfma_f32_16x16x32_bf16 v[92:95], v[152:155], v[156:159], v[92:95]
ds_read_b64_tr_b16 v[134:135], v240 offset:11264
v_mfma_f32_16x16x32_bf16 v[92:95], v[208:211], v[160:163], v[92:95]
ds_read_b128 v[136:139], v238 offset:512
v_mfma_f32_16x16x32_bf16 v[76:79], v[208:211], v[156:159], v[76:79]
ds_read_b128 v[140:143], v238 offset:768
v_mfma_f32_16x16x32_bf16 v[76:79], v[152:155], v[200:203], v[76:79]
ds_read_b128 v[144:147], v238 offset:1024
v_mfma_f32_16x16x32_bf16 v[76:79], v[232:235], v[188:191], v[76:79]
ds_read_b128 v[164:167], v238 offset:1280
v_mfma_f32_16x16x32_bf16 v[60:63], v[232:235], v[204:207], v[60:63]
ds_read_b128 v[184:187], v238 offset:1536
v_mfma_f32_16x16x32_bf16 v[60:63], v[152:155], v[188:191], v[60:63]
ds_read_b128 v[192:195], v238 offset:1792
v_mfma_f32_16x16x32_bf16 v[60:63], v[208:211], v[200:203], v[60:63]
ds_read_b128 v[172:175], v239 offset:0
v_mfma_f32_16x16x32_bf16 v[44:47], v[208:211], v[188:191], v[44:47]
ds_read_b128 v[128:131], v239 offset:256
v_mfma_f32_16x16x32_bf16 v[44:47], v[152:155], v[204:207], v[44:47]
ds_read_b64_tr_b16 v[196:197], v242 offset:6144
v_mfma_f32_16x16x32_bf16 v[44:47], v[232:235], v[168:171], v[44:47]
ds_read_b64_tr_b16 v[198:199], v242 offset:7168
v_mfma_f32_16x16x32_bf16 v[28:31], v[232:235], v[212:215], v[28:31]
ds_read_b64_tr_b16 v[176:177], v242 offset:8192
v_mfma_f32_16x16x32_bf16 v[28:31], v[152:155], v[168:171], v[28:31]
ds_read_b64_tr_b16 v[178:179], v242 offset:9216
v_mfma_f32_16x16x32_bf16 v[28:31], v[208:211], v[204:207], v[28:31]
ds_read_b64_tr_b16 v[148:149], v242 offset:10240
v_mfma_f32_16x16x32_bf16 v[12:15], v[208:211], v[168:171], v[12:15]
ds_read_b64_tr_b16 v[150:151], v242 offset:11264
v_mfma_f32_16x16x32_bf16 v[12:15], v[152:155], v[212:215], v[12:15]
v_mfma_f32_16x16x32_bf16 v[12:15], v[232:235], v[248:251], v[12:15]
s_waitcnt lgkmcnt(14)
v_mfma_f32_16x16x32_bf16 v[0:3], v[216:219], v[220:223], v[0:3]
ds_read_b64_tr_b16 v[180:181], v241 offset:6144
v_mfma_f32_16x16x32_bf16 v[0:3], v[224:227], v[228:231], v[0:3]
s_waitcnt lgkmcnt(14)
ds_read_b64_tr_b16 v[182:183], v241 offset:7168
v_mfma_f32_16x16x32_bf16 v[0:3], v[132:135], v[136:139], v[0:3]
s_waitcnt lgkmcnt(14)
ds_read_b64_tr_b16 v[160:161], v241 offset:8192
v_mfma_f32_16x16x32_bf16 v[16:19], v[132:135], v[140:143], v[16:19]
ds_read_b64_tr_b16 v[162:163], v241 offset:9216
v_mfma_f32_16x16x32_bf16 v[16:19], v[224:227], v[136:139], v[16:19]
ds_read_b64_tr_b16 v[156:157], v241 offset:10240
v_mfma_f32_16x16x32_bf16 v[16:19], v[216:219], v[228:231], v[16:19]
ds_read_b64_tr_b16 v[158:159], v241 offset:11264
v_mfma_f32_16x16x32_bf16 v[32:35], v[216:219], v[136:139], v[32:35]
v_mfma_f32_16x16x32_bf16 v[32:35], v[224:227], v[140:143], v[32:35]
s_waitcnt lgkmcnt(14)
v_mfma_f32_16x16x32_bf16 v[32:35], v[132:135], v[144:147], v[32:35]
v_mfma_f32_16x16x32_bf16 v[48:51], v[132:135], v[164:167], v[48:51]
v_mfma_f32_16x16x32_bf16 v[48:51], v[224:227], v[144:147], v[48:51]
v_mfma_f32_16x16x32_bf16 v[48:51], v[216:219], v[140:143], v[48:51]
v_mfma_f32_16x16x32_bf16 v[64:67], v[216:219], v[144:147], v[64:67]
v_mfma_f32_16x16x32_bf16 v[64:67], v[224:227], v[164:167], v[64:67]
v_mfma_f32_16x16x32_bf16 v[64:67], v[132:135], v[184:187], v[64:67]
v_mfma_f32_16x16x32_bf16 v[80:83], v[132:135], v[192:195], v[80:83]
v_mfma_f32_16x16x32_bf16 v[80:83], v[224:227], v[184:187], v[80:83]
v_mfma_f32_16x16x32_bf16 v[80:83], v[216:219], v[164:167], v[80:83]
v_mfma_f32_16x16x32_bf16 v[96:99], v[216:219], v[184:187], v[96:99]
v_mfma_f32_16x16x32_bf16 v[96:99], v[224:227], v[192:195], v[96:99]
s_waitcnt lgkmcnt(13)
v_mfma_f32_16x16x32_bf16 v[96:99], v[132:135], v[172:175], v[96:99]
s_waitcnt lgkmcnt(12)
v_mfma_f32_16x16x32_bf16 v[112:115], v[132:135], v[128:131], v[112:115]
v_mfma_f32_16x16x32_bf16 v[112:115], v[224:227], v[172:175], v[112:115]
v_mfma_f32_16x16x32_bf16 v[112:115], v[216:219], v[192:195], v[112:115]
s_waitcnt lgkmcnt(10)
v_mfma_f32_16x16x32_bf16 v[120:123], v[196:199], v[192:195], v[120:123]
s_waitcnt lgkmcnt(8)
ds_read_b64_tr_b16 v[200:201], v243 offset:6144
v_mfma_f32_16x16x32_bf16 v[120:123], v[176:179], v[172:175], v[120:123]
s_waitcnt lgkmcnt(7)
ds_read_b64_tr_b16 v[202:203], v243 offset:7168
v_mfma_f32_16x16x32_bf16 v[120:123], v[148:151], v[128:131], v[120:123]
ds_read_b64_tr_b16 v[188:189], v243 offset:8192
v_mfma_f32_16x16x32_bf16 v[104:107], v[148:151], v[172:175], v[104:107]
ds_read_b64_tr_b16 v[190:191], v243 offset:9216
v_mfma_f32_16x16x32_bf16 v[104:107], v[176:179], v[192:195], v[104:107]
ds_read_b64_tr_b16 v[204:205], v243 offset:10240
v_mfma_f32_16x16x32_bf16 v[104:107], v[196:199], v[184:187], v[104:107]
ds_read_b64_tr_b16 v[206:207], v243 offset:11264
v_mfma_f32_16x16x32_bf16 v[88:91], v[196:199], v[164:167], v[88:91]
v_mfma_f32_16x16x32_bf16 v[88:91], v[176:179], v[184:187], v[88:91]
v_mfma_f32_16x16x32_bf16 v[88:91], v[148:151], v[192:195], v[88:91]
v_mfma_f32_16x16x32_bf16 v[72:75], v[148:151], v[184:187], v[72:75]
v_mfma_f32_16x16x32_bf16 v[72:75], v[176:179], v[164:167], v[72:75]
v_mfma_f32_16x16x32_bf16 v[72:75], v[196:199], v[144:147], v[72:75]
v_mfma_f32_16x16x32_bf16 v[56:59], v[196:199], v[140:143], v[56:59]
v_mfma_f32_16x16x32_bf16 v[56:59], v[176:179], v[144:147], v[56:59]
v_mfma_f32_16x16x32_bf16 v[56:59], v[148:151], v[164:167], v[56:59]
v_mfma_f32_16x16x32_bf16 v[40:43], v[148:151], v[144:147], v[40:43]
v_mfma_f32_16x16x32_bf16 v[40:43], v[176:179], v[140:143], v[40:43]
v_mfma_f32_16x16x32_bf16 v[40:43], v[196:199], v[136:139], v[40:43]
v_mfma_f32_16x16x32_bf16 v[24:27], v[196:199], v[228:231], v[24:27]
v_mfma_f32_16x16x32_bf16 v[24:27], v[176:179], v[136:139], v[24:27]
v_mfma_f32_16x16x32_bf16 v[24:27], v[148:151], v[140:143], v[24:27]
v_mfma_f32_16x16x32_bf16 v[8:11], v[148:151], v[136:139], v[8:11]
v_mfma_f32_16x16x32_bf16 v[8:11], v[176:179], v[228:231], v[8:11]
v_mfma_f32_16x16x32_bf16 v[8:11], v[196:199], v[220:223], v[8:11]
s_waitcnt lgkmcnt(10)
v_mfma_f32_16x16x32_bf16 v[4:7], v[180:183], v[220:223], v[4:7]
s_waitcnt lgkmcnt(8)
v_mfma_f32_16x16x32_bf16 v[4:7], v[160:163], v[228:231], v[4:7]
s_waitcnt lgkmcnt(6)
v_mfma_f32_16x16x32_bf16 v[4:7], v[156:159], v[136:139], v[4:7]
v_mfma_f32_16x16x32_bf16 v[20:23], v[156:159], v[140:143], v[20:23]
v_mfma_f32_16x16x32_bf16 v[20:23], v[160:163], v[136:139], v[20:23]
v_mfma_f32_16x16x32_bf16 v[20:23], v[180:183], v[228:231], v[20:23]
v_mfma_f32_16x16x32_bf16 v[36:39], v[180:183], v[136:139], v[36:39]
v_mfma_f32_16x16x32_bf16 v[36:39], v[160:163], v[140:143], v[36:39]
v_mfma_f32_16x16x32_bf16 v[36:39], v[156:159], v[144:147], v[36:39]
v_mfma_f32_16x16x32_bf16 v[52:55], v[156:159], v[164:167], v[52:55]
v_mfma_f32_16x16x32_bf16 v[52:55], v[160:163], v[144:147], v[52:55]
v_mfma_f32_16x16x32_bf16 v[52:55], v[180:183], v[140:143], v[52:55]
v_mfma_f32_16x16x32_bf16 v[68:71], v[180:183], v[144:147], v[68:71]
v_mfma_f32_16x16x32_bf16 v[68:71], v[160:163], v[164:167], v[68:71]
v_mfma_f32_16x16x32_bf16 v[68:71], v[156:159], v[184:187], v[68:71]
v_mfma_f32_16x16x32_bf16 v[84:87], v[156:159], v[192:195], v[84:87]
v_mfma_f32_16x16x32_bf16 v[84:87], v[160:163], v[184:187], v[84:87]
v_mfma_f32_16x16x32_bf16 v[84:87], v[180:183], v[164:167], v[84:87]
v_mfma_f32_16x16x32_bf16 v[100:103], v[180:183], v[184:187], v[100:103]
v_mfma_f32_16x16x32_bf16 v[100:103], v[160:163], v[192:195], v[100:103]
v_mfma_f32_16x16x32_bf16 v[100:103], v[156:159], v[172:175], v[100:103]
v_mfma_f32_16x16x32_bf16 v[116:119], v[156:159], v[128:131], v[116:119]
v_mfma_f32_16x16x32_bf16 v[116:119], v[160:163], v[172:175], v[116:119]
v_mfma_f32_16x16x32_bf16 v[116:119], v[180:183], v[192:195], v[116:119]
s_waitcnt lgkmcnt(4)
s_waitcnt lgkmcnt(2)
s_barrier
v_mfma_f32_16x16x32_bf16 v[124:127], v[200:203], v[192:195], v[124:127]
ds_read_b64_tr_b16 v[208:209], v240 offset:12288
v_mfma_f32_16x16x32_bf16 v[124:127], v[188:191], v[172:175], v[124:127]
s_waitcnt lgkmcnt(1)
ds_read_b64_tr_b16 v[210:211], v240 offset:13312
v_mfma_f32_16x16x32_bf16 v[124:127], v[204:207], v[128:131], v[124:127]
ds_read_b128 v[168:171], v236 offset:32768
v_mfma_f32_16x16x32_bf16 v[108:111], v[204:207], v[172:175], v[108:111]
ds_read_b64_tr_b16 v[152:153], v240 offset:14336
v_mfma_f32_16x16x32_bf16 v[108:111], v[188:191], v[192:195], v[108:111]
ds_read_b64_tr_b16 v[154:155], v240 offset:15360
v_mfma_f32_16x16x32_bf16 v[108:111], v[200:203], v[184:187], v[108:111]
ds_read_b128 v[212:215], v236 offset:33024
v_mfma_f32_16x16x32_bf16 v[92:95], v[200:203], v[164:167], v[92:95]
ds_read_b64_tr_b16 v[232:233], v240 offset:16384
v_mfma_f32_16x16x32_bf16 v[92:95], v[188:191], v[184:187], v[92:95]
ds_read_b64_tr_b16 v[234:235], v240 offset:17408
v_mfma_f32_16x16x32_bf16 v[92:95], v[204:207], v[192:195], v[92:95]
ds_read_b128 v[248:251], v236 offset:33280
v_mfma_f32_16x16x32_bf16 v[76:79], v[204:207], v[184:187], v[76:79]
ds_read_b128 v[132:135], v236 offset:33536
v_mfma_f32_16x16x32_bf16 v[76:79], v[188:191], v[164:167], v[76:79]
ds_read_b128 v[224:227], v236 offset:33792
v_mfma_f32_16x16x32_bf16 v[76:79], v[200:203], v[144:147], v[76:79]
ds_read_b128 v[216:219], v236 offset:34048
v_mfma_f32_16x16x32_bf16 v[60:63], v[200:203], v[140:143], v[60:63]
ds_read_b128 v[148:151], v236 offset:34304
v_mfma_f32_16x16x32_bf16 v[60:63], v[188:191], v[144:147], v[60:63]
ds_read_b128 v[176:179], v236 offset:34560
v_mfma_f32_16x16x32_bf16 v[60:63], v[204:207], v[164:167], v[60:63]
ds_read_b128 v[196:199], v237 offset:32768
v_mfma_f32_16x16x32_bf16 v[44:47], v[204:207], v[144:147], v[44:47]
ds_read_b128 v[156:159], v237 offset:33024
v_mfma_f32_16x16x32_bf16 v[44:47], v[188:191], v[140:143], v[44:47]
ds_read_b64_tr_b16 v[160:161], v242 offset:12288
v_mfma_f32_16x16x32_bf16 v[44:47], v[200:203], v[136:139], v[44:47]
ds_read_b64_tr_b16 v[162:163], v242 offset:13312
v_mfma_f32_16x16x32_bf16 v[28:31], v[200:203], v[228:231], v[28:31]
ds_read_b64_tr_b16 v[180:181], v242 offset:14336
v_mfma_f32_16x16x32_bf16 v[28:31], v[188:191], v[136:139], v[28:31]
ds_read_b64_tr_b16 v[182:183], v242 offset:15360
v_mfma_f32_16x16x32_bf16 v[28:31], v[204:207], v[140:143], v[28:31]
ds_read_b64_tr_b16 v[128:129], v242 offset:16384
v_mfma_f32_16x16x32_bf16 v[12:15], v[204:207], v[136:139], v[12:15]
ds_read_b64_tr_b16 v[130:131], v242 offset:17408
v_mfma_f32_16x16x32_bf16 v[12:15], v[188:191], v[228:231], v[12:15]
v_mfma_f32_16x16x32_bf16 v[12:15], v[200:203], v[220:223], v[12:15]
s_waitcnt lgkmcnt(14)
v_mfma_f32_16x16x32_bf16 v[0:3], v[208:211], v[168:171], v[0:3]
ds_read_b64_tr_b16 v[172:173], v241 offset:12288
v_mfma_f32_16x16x32_bf16 v[0:3], v[152:155], v[212:215], v[0:3]
s_waitcnt lgkmcnt(14)
ds_read_b64_tr_b16 v[174:175], v241 offset:13312
v_mfma_f32_16x16x32_bf16 v[0:3], v[232:235], v[248:251], v[0:3]
s_waitcnt lgkmcnt(14)
ds_read_b64_tr_b16 v[192:193], v241 offset:14336
v_mfma_f32_16x16x32_bf16 v[16:19], v[232:235], v[132:135], v[16:19]
ds_read_b64_tr_b16 v[194:195], v241 offset:15360
v_mfma_f32_16x16x32_bf16 v[16:19], v[152:155], v[248:251], v[16:19]
ds_read_b64_tr_b16 v[184:185], v241 offset:16384
v_mfma_f32_16x16x32_bf16 v[16:19], v[208:211], v[212:215], v[16:19]
ds_read_b64_tr_b16 v[186:187], v241 offset:17408
v_mfma_f32_16x16x32_bf16 v[32:35], v[208:211], v[248:251], v[32:35]
v_mfma_f32_16x16x32_bf16 v[32:35], v[152:155], v[132:135], v[32:35]
s_waitcnt lgkmcnt(14)
v_mfma_f32_16x16x32_bf16 v[32:35], v[232:235], v[224:227], v[32:35]
v_mfma_f32_16x16x32_bf16 v[48:51], v[232:235], v[216:219], v[48:51]
v_mfma_f32_16x16x32_bf16 v[48:51], v[152:155], v[224:227], v[48:51]
v_mfma_f32_16x16x32_bf16 v[48:51], v[208:211], v[132:135], v[48:51]
v_mfma_f32_16x16x32_bf16 v[64:67], v[208:211], v[224:227], v[64:67]
v_mfma_f32_16x16x32_bf16 v[64:67], v[152:155], v[216:219], v[64:67]
v_mfma_f32_16x16x32_bf16 v[64:67], v[232:235], v[148:151], v[64:67]
v_mfma_f32_16x16x32_bf16 v[80:83], v[232:235], v[176:179], v[80:83]
v_mfma_f32_16x16x32_bf16 v[80:83], v[152:155], v[148:151], v[80:83]
v_mfma_f32_16x16x32_bf16 v[80:83], v[208:211], v[216:219], v[80:83]
v_mfma_f32_16x16x32_bf16 v[96:99], v[208:211], v[148:151], v[96:99]
v_mfma_f32_16x16x32_bf16 v[96:99], v[152:155], v[176:179], v[96:99]
s_waitcnt lgkmcnt(13)
v_mfma_f32_16x16x32_bf16 v[96:99], v[232:235], v[196:199], v[96:99]
s_waitcnt lgkmcnt(12)
v_mfma_f32_16x16x32_bf16 v[112:115], v[232:235], v[156:159], v[112:115]
v_mfma_f32_16x16x32_bf16 v[112:115], v[152:155], v[196:199], v[112:115]
v_mfma_f32_16x16x32_bf16 v[112:115], v[208:211], v[176:179], v[112:115]
s_waitcnt lgkmcnt(10)
v_mfma_f32_16x16x32_bf16 v[120:123], v[160:163], v[176:179], v[120:123]
s_waitcnt lgkmcnt(8)
ds_read_b64_tr_b16 v[164:165], v243 offset:12288
v_mfma_f32_16x16x32_bf16 v[120:123], v[180:183], v[196:199], v[120:123]
s_waitcnt lgkmcnt(7)
ds_read_b64_tr_b16 v[166:167], v243 offset:13312
v_mfma_f32_16x16x32_bf16 v[120:123], v[128:131], v[156:159], v[120:123]
ds_read_b64_tr_b16 v[144:145], v243 offset:14336
v_mfma_f32_16x16x32_bf16 v[104:107], v[128:131], v[196:199], v[104:107]
ds_read_b64_tr_b16 v[146:147], v243 offset:15360
v_mfma_f32_16x16x32_bf16 v[104:107], v[180:183], v[176:179], v[104:107]
ds_read_b64_tr_b16 v[140:141], v243 offset:16384
v_mfma_f32_16x16x32_bf16 v[104:107], v[160:163], v[148:151], v[104:107]
L_pad3:
s_cmp_eq_u32 s79, 1
s_cbranch_scc1 L_lret3
ds_read_b64_tr_b16 v[142:143], v243 offset:17408
v_mfma_f32_16x16x32_bf16 v[88:91], v[160:163], v[216:219], v[88:91]
v_mfma_f32_16x16x32_bf16 v[88:91], v[180:183], v[148:151], v[88:91]
v_mfma_f32_16x16x32_bf16 v[88:91], v[128:131], v[176:179], v[88:91]
v_mfma_f32_16x16x32_bf16 v[72:75], v[128:131], v[148:151], v[72:75]
v_mfma_f32_16x16x32_bf16 v[72:75], v[180:183], v[216:219], v[72:75]
v_mfma_f32_16x16x32_bf16 v[72:75], v[160:163], v[224:227], v[72:75]
v_mfma_f32_16x16x32_bf16 v[56:59], v[160:163], v[132:135], v[56:59]
v_mfma_f32_16x16x32_bf16 v[56:59], v[180:183], v[224:227], v[56:59]
v_mfma_f32_16x16x32_bf16 v[56:59], v[128:131], v[216:219], v[56:59]
v_mfma_f32_16x16x32_bf16 v[40:43], v[128:131], v[224:227], v[40:43]
v_mfma_f32_16x16x32_bf16 v[40:43], v[180:183], v[132:135], v[40:43]
v_mfma_f32_16x16x32_bf16 v[40:43], v[160:163], v[248:251], v[40:43]
v_mfma_f32_16x16x32_bf16 v[24:27], v[160:163], v[212:215], v[24:27]
v_mfma_f32_16x16x32_bf16 v[24:27], v[180:183], v[248:251], v[24:27]
v_mfma_f32_16x16x32_bf16 v[24:27], v[128:131], v[132:135], v[24:27]
v_mfma_f32_16x16x32_bf16 v[8:11], v[128:131], v[248:251], v[8:11]
v_mfma_f32_16x16x32_bf16 v[8:11], v[180:183], v[212:215], v[8:11]
v_mfma_f32_16x16x32_bf16 v[8:11], v[160:163], v[168:171], v[8:11]
s_waitcnt lgkmcnt(10)
v_mfma_f32_16x16x32_bf16 v[4:7], v[172:175], v[168:171], v[4:7]
s_waitcnt lgkmcnt(8)
v_mfma_f32_16x16x32_bf16 v[4:7], v[192:195], v[212:215], v[4:7]
s_waitcnt lgkmcnt(6)
v_mfma_f32_16x16x32_bf16 v[4:7], v[184:187], v[248:251], v[4:7]
v_mfma_f32_16x16x32_bf16 v[20:23], v[184:187], v[132:135], v[20:23]
v_mfma_f32_16x16x32_bf16 v[20:23], v[192:195], v[248:251], v[20:23]
v_mfma_f32_16x16x32_bf16 v[20:23], v[172:175], v[212:215], v[20:23]
v_mfma_f32_16x16x32_bf16 v[36:39], v[172:175], v[248:251], v[36:39]
v_mfma_f32_16x16x32_bf16 v[36:39], v[192:195], v[132:135], v[36:39]
v_mfma_f32_16x16x32_bf16 v[36:39], v[184:187], v[224:227], v[36:39]
v_mfma_f32_16x16x32_bf16 v[52:55], v[184:187], v[216:219], v[52:55]
v_mfma_f32_16x16x32_bf16 v[52:55], v[192:195], v[224:227], v[52:55]
v_mfma_f32_16x16x32_bf16 v[52:55], v[172:175], v[132:135], v[52:55]
v_mfma_f32_16x16x32_bf16 v[68:71], v[172:175], v[224:227], v[68:71]
v_mfma_f32_16x16x32_bf16 v[68:71], v[192:195], v[216:219], v[68:71]
v_mfma_f32_16x16x32_bf16 v[68:71], v[184:187], v[148:151], v[68:71]
v_mfma_f32_16x16x32_bf16 v[84:87], v[184:187], v[176:179], v[84:87]
v_mfma_f32_16x16x32_bf16 v[84:87], v[192:195], v[148:151], v[84:87]
v_mfma_f32_16x16x32_bf16 v[84:87], v[172:175], v[216:219], v[84:87]
v_mfma_f32_16x16x32_bf16 v[100:103], v[172:175], v[148:151], v[100:103]
v_mfma_f32_16x16x32_bf16 v[100:103], v[192:195], v[176:179], v[100:103]
v_mfma_f32_16x16x32_bf16 v[100:103], v[184:187], v[196:199], v[100:103]
v_mfma_f32_16x16x32_bf16 v[116:119], v[184:187], v[156:159], v[116:119]
v_mfma_f32_16x16x32_bf16 v[116:119], v[192:195], v[196:199], v[116:119]
v_mfma_f32_16x16x32_bf16 v[116:119], v[172:175], v[176:179], v[116:119]
s_waitcnt lgkmcnt(4)
s_barrier
ds_read_b64_tr_b16 v[204:205], v240 offset:18432
v_mfma_f32_16x16x32_bf16 v[124:127], v[164:167], v[176:179], v[124:127]
s_waitcnt lgkmcnt(3)
ds_read_b64_tr_b16 v[206:207], v240 offset:19456
v_mfma_f32_16x16x32_bf16 v[124:127], v[144:147], v[196:199], v[124:127]
s_waitcnt lgkmcnt(2)
ds_read_b128 v[136:139], v238 offset:32768
v_mfma_f32_16x16x32_bf16 v[124:127], v[140:143], v[156:159], v[124:127]
ds_read_b64_tr_b16 v[188:189], v240 offset:20480
v_mfma_f32_16x16x32_bf16 v[108:111], v[140:143], v[196:199], v[108:111]
ds_read_b64_tr_b16 v[190:191], v240 offset:21504
v_mfma_f32_16x16x32_bf16 v[108:111], v[144:147], v[176:179], v[108:111]
ds_read_b128 v[228:231], v238 offset:33024
v_mfma_f32_16x16x32_bf16 v[108:111], v[164:167], v[148:151], v[108:111]
ds_read_b64_tr_b16 v[200:201], v240 offset:22528
v_mfma_f32_16x16x32_bf16 v[92:95], v[164:167], v[216:219], v[92:95]
ds_read_b64_tr_b16 v[202:203], v240 offset:23552
v_mfma_f32_16x16x32_bf16 v[92:95], v[144:147], v[148:151], v[92:95]
ds_read_b128 v[220:223], v238 offset:33280
v_mfma_f32_16x16x32_bf16 v[92:95], v[140:143], v[176:179], v[92:95]
ds_read_b128 v[232:235], v238 offset:33536
v_mfma_f32_16x16x32_bf16 v[76:79], v[140:143], v[148:151], v[76:79]
ds_read_b128 v[152:155], v238 offset:33792
v_mfma_f32_16x16x32_bf16 v[76:79], v[144:147], v[216:219], v[76:79]
ds_read_b128 v[208:211], v238 offset:34048
v_mfma_f32_16x16x32_bf16 v[76:79], v[164:167], v[224:227], v[76:79]
ds_read_b128 v[128:131], v238 offset:34304
v_mfma_f32_16x16x32_bf16 v[60:63], v[164:167], v[132:135], v[60:63]
ds_read_b128 v[180:183], v238 offset:34560
v_mfma_f32_16x16x32_bf16 v[60:63], v[144:147], v[224:227], v[60:63]
ds_read_b128 v[160:163], v239 offset:32768
v_mfma_f32_16x16x32_bf16 v[60:63], v[140:143], v[216:219], v[60:63]
ds_read_b128 v[184:187], v239 offset:33024
v_mfma_f32_16x16x32_bf16 v[44:47], v[140:143], v[224:227], v[44:47]
ds_read_b64_tr_b16 v[192:193], v242 offset:18432
v_mfma_f32_16x16x32_bf16 v[44:47], v[144:147], v[132:135], v[44:47]
ds_read_b64_tr_b16 v[194:195], v242 offset:19456
v_mfma_f32_16x16x32_bf16 v[44:47], v[164:167], v[248:251], v[44:47]
ds_read_b64_tr_b16 v[172:173], v242 offset:20480
v_mfma_f32_16x16x32_bf16 v[28:31], v[164:167], v[212:215], v[28:31]
ds_read_b64_tr_b16 v[174:175], v242 offset:21504
v_mfma_f32_16x16x32_bf16 v[28:31], v[144:147], v[248:251], v[28:31]
ds_read_b64_tr_b16 v[156:157], v242 offset:22528
v_mfma_f32_16x16x32_bf16 v[28:31], v[140:143], v[132:135], v[28:31]
ds_read_b64_tr_b16 v[158:159], v242 offset:23552
v_mfma_f32_16x16x32_bf16 v[12:15], v[140:143], v[248:251], v[12:15]
v_mfma_f32_16x16x32_bf16 v[12:15], v[144:147], v[212:215], v[12:15]
v_mfma_f32_16x16x32_bf16 v[12:15], v[164:167], v[168:171], v[12:15]
s_waitcnt lgkmcnt(14)
v_mfma_f32_16x16x32_bf16 v[0:3], v[204:207], v[136:139], v[0:3]
ds_read_b64_tr_b16 v[196:197], v241 offset:18432
v_mfma_f32_16x16x32_bf16 v[0:3], v[188:191], v[228:231], v[0:3]
s_waitcnt lgkmcnt(14)
ds_read_b64_tr_b16 v[198:199], v241 offset:19456
v_mfma_f32_16x16x32_bf16 v[0:3], v[200:203], v[220:223], v[0:3]
s_waitcnt lgkmcnt(14)
ds_read_b64_tr_b16 v[176:177], v241 offset:20480
v_mfma_f32_16x16x32_bf16 v[16:19], v[200:203], v[232:235], v[16:19]
ds_read_b64_tr_b16 v[178:179], v241 offset:21504
v_mfma_f32_16x16x32_bf16 v[16:19], v[188:191], v[220:223], v[16:19]
ds_read_b64_tr_b16 v[148:149], v241 offset:22528
v_mfma_f32_16x16x32_bf16 v[16:19], v[204:207], v[228:231], v[16:19]
ds_read_b64_tr_b16 v[150:151], v241 offset:23552
v_mfma_f32_16x16x32_bf16 v[32:35], v[204:207], v[220:223], v[32:35]
v_mfma_f32_16x16x32_bf16 v[32:35], v[188:191], v[232:235], v[32:35]
s_waitcnt lgkmcnt(14)
v_mfma_f32_16x16x32_bf16 v[32:35], v[200:203], v[152:155], v[32:35]
v_mfma_f32_16x16x32_bf16 v[48:51], v[200:203], v[208:211], v[48:51]
v_mfma_f32_16x16x32_bf16 v[48:51], v[188:191], v[152:155], v[48:51]
v_mfma_f32_16x16x32_bf16 v[48:51], v[204:207], v[232:235], v[48:51]
s_waitcnt lgkmcnt(12)
s_barrier
v_mfma_f32_16x16x32_bf16 v[64:67], v[204:207], v[152:155], v[64:67]
v_mfma_f32_16x16x32_bf16 v[64:67], v[188:191], v[208:211], v[64:67]
v_mfma_f32_16x16x32_bf16 v[64:67], v[200:203], v[128:131], v[64:67]
v_mfma_f32_16x16x32_bf16 v[80:83], v[200:203], v[180:183], v[80:83]
v_mfma_f32_16x16x32_bf16 v[80:83], v[188:191], v[128:131], v[80:83]
v_mfma_f32_16x16x32_bf16 v[80:83], v[204:207], v[208:211], v[80:83]
v_mfma_f32_16x16x32_bf16 v[96:99], v[204:207], v[128:131], v[96:99]
v_mfma_f32_16x16x32_bf16 v[96:99], v[188:191], v[180:183], v[96:99]
v_mfma_f32_16x16x32_bf16 v[96:99], v[200:203], v[160:163], v[96:99]
v_mfma_f32_16x16x32_bf16 v[112:115], v[200:203], v[184:187], v[112:115]
v_mfma_f32_16x16x32_bf16 v[112:115], v[188:191], v[160:163], v[112:115]
v_mfma_f32_16x16x32_bf16 v[112:115], v[204:207], v[180:183], v[112:115]
s_waitcnt lgkmcnt(10)
v_mfma_f32_16x16x32_bf16 v[120:123], v[192:195], v[180:183], v[120:123]
s_waitcnt lgkmcnt(8)
ds_read_b64_tr_b16 v[216:217], v243 offset:18432
v_mfma_f32_16x16x32_bf16 v[120:123], v[172:175], v[160:163], v[120:123]
s_waitcnt lgkmcnt(7)
ds_read_b64_tr_b16 v[218:219], v243 offset:19456
v_mfma_f32_16x16x32_bf16 v[120:123], v[156:159], v[184:187], v[120:123]
ds_read_b64_tr_b16 v[224:225], v243 offset:20480
v_mfma_f32_16x16x32_bf16 v[104:107], v[156:159], v[160:163], v[104:107]
ds_read_b64_tr_b16 v[226:227], v243 offset:21504
v_mfma_f32_16x16x32_bf16 v[104:107], v[172:175], v[180:183], v[104:107]
ds_read_b64_tr_b16 v[132:133], v243 offset:22528
v_mfma_f32_16x16x32_bf16 v[104:107], v[192:195], v[128:131], v[104:107]
ds_read_b64_tr_b16 v[134:135], v243 offset:23552
v_mfma_f32_16x16x32_bf16 v[88:91], v[192:195], v[208:211], v[88:91]
v_mfma_f32_16x16x32_bf16 v[88:91], v[172:175], v[128:131], v[88:91]
v_mfma_f32_16x16x32_bf16 v[88:91], v[156:159], v[180:183], v[88:91]
v_mfma_f32_16x16x32_bf16 v[72:75], v[156:159], v[128:131], v[72:75]
v_mfma_f32_16x16x32_bf16 v[72:75], v[172:175], v[208:211], v[72:75]
v_mfma_f32_16x16x32_bf16 v[72:75], v[192:195], v[152:155], v[72:75]
v_mfma_f32_16x16x32_bf16 v[56:59], v[192:195], v[232:235], v[56:59]
v_mfma_f32_16x16x32_bf16 v[56:59], v[172:175], v[152:155], v[56:59]
v_mfma_f32_16x16x32_bf16 v[56:59], v[156:159], v[208:211], v[56:59]
v_mfma_f32_16x16x32_bf16 v[40:43], v[156:159], v[152:155], v[40:43]
v_mfma_f32_16x16x32_bf16 v[40:43], v[172:175], v[232:235], v[40:43]
v_mfma_f32_16x16x32_bf16 v[40:43], v[192:195], v[220:223], v[40:43]
v_mfma_f32_16x16x32_bf16 v[24:27], v[192:195], v[228:231], v[24:27]
v_mfma_f32_16x16x32_bf16 v[24:27], v[172:175], v[220:223], v[24:27]
v_mfma_f32_16x16x32_bf16 v[24:27], v[156:159], v[232:235], v[24:27]
v_mfma_f32_16x16x32_bf16 v[8:11], v[156:159], v[220:223], v[8:11]
v_mfma_f32_16x16x32_bf16 v[8:11], v[172:175], v[228:231], v[8:11]
v_mfma_f32_16x16x32_bf16 v[8:11], v[192:195], v[136:139], v[8:11]
s_waitcnt lgkmcnt(10)
v_mfma_f32_16x16x32_bf16 v[4:7], v[196:199], v[136:139], v[4:7]
s_waitcnt lgkmcnt(8)
v_mfma_f32_16x16x32_bf16 v[4:7], v[176:179], v[228:231], v[4:7]
s_waitcnt lgkmcnt(6)
v_mfma_f32_16x16x32_bf16 v[4:7], v[148:151], v[220:223], v[4:7]
v_mfma_f32_16x16x32_bf16 v[20:23], v[148:151], v[232:235], v[20:23]
v_mfma_f32_16x16x32_bf16 v[20:23], v[176:179], v[220:223], v[20:23]
v_mfma_f32_16x16x32_bf16 v[20:23], v[196:199], v[228:231], v[20:23]
v_mfma_f32_16x16x32_bf16 v[36:39], v[196:199], v[220:223], v[36:39]
v_mfma_f32_16x16x32_bf16 v[36:39], v[176:179], v[232:235], v[36:39]
v_mfma_f32_16x16x32_bf16 v[36:39], v[148:151], v[152:155], v[36:39]
v_mfma_f32_16x16x32_bf16 v[52:55], v[148:151], v[208:211], v[52:55]
v_mfma_f32_16x16x32_bf16 v[52:55], v[176:179], v[152:155], v[52:55]
v_mfma_f32_16x16x32_bf16 v[52:55], v[196:199], v[232:235], v[52:55]
v_mfma_f32_16x16x32_bf16 v[68:71], v[196:199], v[152:155], v[68:71]
v_mfma_f32_16x16x32_bf16 v[68:71], v[176:179], v[208:211], v[68:71]
v_mfma_f32_16x16x32_bf16 v[68:71], v[148:151], v[128:131], v[68:71]
v_mfma_f32_16x16x32_bf16 v[84:87], v[148:151], v[180:183], v[84:87]
v_mfma_f32_16x16x32_bf16 v[84:87], v[176:179], v[128:131], v[84:87]
v_mfma_f32_16x16x32_bf16 v[84:87], v[196:199], v[208:211], v[84:87]
v_mfma_f32_16x16x32_bf16 v[100:103], v[196:199], v[128:131], v[100:103]
v_mfma_f32_16x16x32_bf16 v[100:103], v[176:179], v[180:183], v[100:103]
v_mfma_f32_16x16x32_bf16 v[100:103], v[148:151], v[160:163], v[100:103]
v_mfma_f32_16x16x32_bf16 v[116:119], v[148:151], v[184:187], v[116:119]
v_mfma_f32_16x16x32_bf16 v[116:119], v[176:179], v[160:163], v[116:119]
v_mfma_f32_16x16x32_bf16 v[116:119], v[196:199], v[180:183], v[116:119]
s_waitcnt lgkmcnt(4)
s_waitcnt lgkmcnt(0)
s_barrier
v_mfma_f32_16x16x32_bf16 v[124:127], v[216:219], v[180:183], v[124:127]
ds_read_b64_tr_b16 v[140:141], v240 offset:0
v_mfma_f32_16x16x32_bf16 v[124:127], v[224:227], v[160:163], v[124:127]
ds_read_b64_tr_b16 v[142:143], v240 offset:1024
v_mfma_f32_16x16x32_bf16 v[124:127], v[132:135], v[184:187], v[124:127]
ds_read_b128 v[248:251], v236 offset:0
v_mfma_f32_16x16x32_bf16 v[108:111], v[132:135], v[160:163], v[108:111]
ds_read_b64_tr_b16 v[144:145], v240 offset:2048
v_mfma_f32_16x16x32_bf16 v[108:111], v[224:227], v[180:183], v[108:111]
ds_read_b64_tr_b16 v[146:147], v240 offset:3072
v_mfma_f32_16x16x32_bf16 v[108:111], v[216:219], v[128:131], v[108:111]
ds_read_b128 v[212:215], v236 offset:256
v_mfma_f32_16x16x32_bf16 v[92:95], v[216:219], v[208:211], v[92:95]
ds_read_b64_tr_b16 v[164:165], v240 offset:4096
v_mfma_f32_16x16x32_bf16 v[92:95], v[224:227], v[128:131], v[92:95]
ds_read_b64_tr_b16 v[166:167], v240 offset:5120
v_mfma_f32_16x16x32_bf16 v[92:95], v[132:135], v[180:183], v[92:95]
ds_read_b128 v[168:171], v236 offset:512
v_mfma_f32_16x16x32_bf16 v[76:79], v[132:135], v[128:131], v[76:79]
ds_read_b128 v[200:203], v236 offset:768
v_mfma_f32_16x16x32_bf16 v[76:79], v[224:227], v[208:211], v[76:79]
ds_read_b128 v[188:191], v236 offset:1024
v_mfma_f32_16x16x32_bf16 v[76:79], v[216:219], v[152:155], v[76:79]
ds_read_b64_tr_b16 v[204:205], v242 offset:4096
v_mfma_f32_16x16x32_bf16 v[60:63], v[216:219], v[232:235], v[60:63]
ds_read_b64_tr_b16 v[206:207], v242 offset:5120
v_mfma_f32_16x16x32_bf16 v[60:63], v[224:227], v[152:155], v[60:63]
ds_read_b64_tr_b16 v[156:157], v242 offset:2048
v_mfma_f32_16x16x32_bf16 v[60:63], v[132:135], v[208:211], v[60:63]
ds_read_b64_tr_b16 v[158:159], v242 offset:3072
v_mfma_f32_16x16x32_bf16 v[44:47], v[132:135], v[152:155], v[44:47]
ds_read_b64_tr_b16 v[172:173], v242 offset:0
v_mfma_f32_16x16x32_bf16 v[44:47], v[224:227], v[232:235], v[44:47]
ds_read_b64_tr_b16 v[174:175], v242 offset:1024
v_mfma_f32_16x16x32_bf16 v[44:47], v[216:219], v[220:223], v[44:47]
ds_read_b64_tr_b16 v[192:193], v241 offset:0
v_mfma_f32_16x16x32_bf16 v[28:31], v[216:219], v[228:231], v[28:31]
ds_read_b64_tr_b16 v[194:195], v241 offset:1024
v_mfma_f32_16x16x32_bf16 v[28:31], v[224:227], v[220:223], v[28:31]
ds_read_b64_tr_b16 v[148:149], v241 offset:2048
v_mfma_f32_16x16x32_bf16 v[28:31], v[132:135], v[232:235], v[28:31]
ds_read_b64_tr_b16 v[150:151], v241 offset:3072
v_mfma_f32_16x16x32_bf16 v[12:15], v[132:135], v[220:223], v[12:15]
ds_read_b64_tr_b16 v[176:177], v241 offset:4096
v_mfma_f32_16x16x32_bf16 v[12:15], v[224:227], v[228:231], v[12:15]
ds_read_b64_tr_b16 v[178:179], v241 offset:5120
v_mfma_f32_16x16x32_bf16 v[12:15], v[216:219], v[136:139], v[12:15]
s_waitcnt lgkmcnt(14)
ds_read_b64_tr_b16 v[196:197], v243 offset:4096
v_mfma_f32_16x16x32_bf16 v[0:3], v[140:143], v[248:251], v[0:3]
ds_read_b64_tr_b16 v[198:199], v243 offset:5120
v_mfma_f32_16x16x32_bf16 v[0:3], v[144:147], v[212:215], v[0:3]
ds_read_b64_tr_b16 v[184:185], v243 offset:2048
v_mfma_f32_16x16x32_bf16 v[0:3], v[164:167], v[168:171], v[0:3]
s_waitcnt lgkmcnt(14)
ds_read_b64_tr_b16 v[186:187], v243 offset:3072
v_mfma_f32_16x16x32_bf16 v[16:19], v[164:167], v[200:203], v[16:19]
ds_read_b64_tr_b16 v[160:161], v243 offset:0
v_mfma_f32_16x16x32_bf16 v[16:19], v[144:147], v[168:171], v[16:19]
ds_read_b64_tr_b16 v[162:163], v243 offset:1024
v_mfma_f32_16x16x32_bf16 v[16:19], v[140:143], v[212:215], v[16:19]
ds_read_b64_tr_b16 v[180:181], v240 offset:6144
v_mfma_f32_16x16x32_bf16 v[32:35], v[140:143], v[168:171], v[32:35]
ds_read_b64_tr_b16 v[182:183], v240 offset:7168
v_mfma_f32_16x16x32_bf16 v[32:35], v[144:147], v[200:203], v[32:35]
ds_read_b128 v[128:131], v238 offset:0
v_mfma_f32_16x16x32_bf16 v[32:35], v[164:167], v[188:191], v[32:35]
s_waitcnt lgkmcnt(14)
ds_read_b64_tr_b16 v[208:209], v240 offset:8192
v_mfma_f32_16x16x32_bf16 v[40:43], v[204:207], v[188:191], v[40:43]
ds_read_b64_tr_b16 v[210:211], v240 offset:9216
v_mfma_f32_16x16x32_bf16 v[40:43], v[156:159], v[200:203], v[40:43]
ds_read_b128 v[152:155], v238 offset:256
v_mfma_f32_16x16x32_bf16 v[40:43], v[172:175], v[168:171], v[40:43]
ds_read_b64_tr_b16 v[232:233], v240 offset:10240
v_mfma_f32_16x16x32_bf16 v[24:27], v[172:175], v[212:215], v[24:27]
ds_read_b64_tr_b16 v[234:235], v240 offset:11264
v_mfma_f32_16x16x32_bf16 v[24:27], v[156:159], v[168:171], v[24:27]
ds_read_b128 v[132:135], v238 offset:512
v_mfma_f32_16x16x32_bf16 v[24:27], v[204:207], v[200:203], v[24:27]
ds_read_b128 v[220:223], v238 offset:768
v_mfma_f32_16x16x32_bf16 v[8:11], v[204:207], v[168:171], v[8:11]
ds_read_b128 v[224:227], v238 offset:1024
v_mfma_f32_16x16x32_bf16 v[8:11], v[156:159], v[212:215], v[8:11]
ds_read_b64_tr_b16 v[228:229], v242 offset:10240
v_mfma_f32_16x16x32_bf16 v[8:11], v[172:175], v[248:251], v[8:11]
s_waitcnt lgkmcnt(14)
ds_read_b64_tr_b16 v[230:231], v242 offset:11264
v_mfma_f32_16x16x32_bf16 v[4:7], v[192:195], v[248:251], v[4:7]
ds_read_b64_tr_b16 v[216:217], v242 offset:8192
v_mfma_f32_16x16x32_bf16 v[4:7], v[148:151], v[212:215], v[4:7]
ds_read_b64_tr_b16 v[218:219], v242 offset:9216
v_mfma_f32_16x16x32_bf16 v[4:7], v[176:179], v[168:171], v[4:7]
ds_read_b64_tr_b16 v[136:137], v242 offset:6144
v_mfma_f32_16x16x32_bf16 v[20:23], v[176:179], v[200:203], v[20:23]
ds_read_b64_tr_b16 v[138:139], v242 offset:7168
v_mfma_f32_16x16x32_bf16 v[20:23], v[148:151], v[168:171], v[20:23]
ds_read_b64_tr_b16 v[140:141], v241 offset:6144
v_mfma_f32_16x16x32_bf16 v[20:23], v[192:195], v[212:215], v[20:23]
ds_read_b64_tr_b16 v[142:143], v241 offset:7168
v_mfma_f32_16x16x32_bf16 v[36:39], v[192:195], v[168:171], v[36:39]
ds_read_b64_tr_b16 v[144:145], v241 offset:8192
v_mfma_f32_16x16x32_bf16 v[36:39], v[148:151], v[200:203], v[36:39]
ds_read_b64_tr_b16 v[146:147], v241 offset:9216
v_mfma_f32_16x16x32_bf16 v[36:39], v[176:179], v[188:191], v[36:39]
ds_read_b64_tr_b16 v[164:165], v241 offset:10240
v_mfma_f32_16x16x32_bf16 v[44:47], v[196:199], v[188:191], v[44:47]
ds_read_b64_tr_b16 v[166:167], v241 offset:11264
v_mfma_f32_16x16x32_bf16 v[44:47], v[184:187], v[200:203], v[44:47]
s_waitcnt lgkmcnt(14)
ds_read_b64_tr_b16 v[204:205], v243 offset:10240
v_mfma_f32_16x16x32_bf16 v[44:47], v[160:163], v[168:171], v[44:47]
ds_read_b64_tr_b16 v[206:207], v243 offset:11264
v_mfma_f32_16x16x32_bf16 v[28:31], v[160:163], v[212:215], v[28:31]
ds_read_b64_tr_b16 v[156:157], v243 offset:8192
v_mfma_f32_16x16x32_bf16 v[28:31], v[184:187], v[168:171], v[28:31]
ds_read_b64_tr_b16 v[158:159], v243 offset:9216
v_mfma_f32_16x16x32_bf16 v[28:31], v[196:199], v[200:203], v[28:31]
ds_read_b64_tr_b16 v[172:173], v243 offset:6144
v_mfma_f32_16x16x32_bf16 v[12:15], v[196:199], v[168:171], v[12:15]
ds_read_b64_tr_b16 v[174:175], v243 offset:7168
v_mfma_f32_16x16x32_bf16 v[12:15], v[184:187], v[212:215], v[12:15]
v_mfma_f32_16x16x32_bf16 v[12:15], v[160:163], v[248:251], v[12:15]
v_mfma_f32_16x16x32_bf16 v[0:3], v[180:183], v[128:131], v[0:3]
v_mfma_f32_16x16x32_bf16 v[0:3], v[208:211], v[152:155], v[0:3]
v_mfma_f32_16x16x32_bf16 v[0:3], v[232:235], v[132:135], v[0:3]
s_waitcnt lgkmcnt(14)
v_mfma_f32_16x16x32_bf16 v[16:19], v[232:235], v[220:223], v[16:19]
v_mfma_f32_16x16x32_bf16 v[16:19], v[208:211], v[132:135], v[16:19]
v_mfma_f32_16x16x32_bf16 v[16:19], v[180:183], v[152:155], v[16:19]
v_mfma_f32_16x16x32_bf16 v[32:35], v[180:183], v[132:135], v[32:35]
v_mfma_f32_16x16x32_bf16 v[32:35], v[208:211], v[220:223], v[32:35]
s_barrier
ds_read_b64_tr_b16 v[192:193], v240 offset:12288
v_mfma_f32_16x16x32_bf16 v[32:35], v[232:235], v[224:227], v[32:35]
ds_read_b64_tr_b16 v[194:195], v240 offset:13312
v_mfma_f32_16x16x32_bf16 v[40:43], v[228:231], v[224:227], v[40:43]
ds_read_b128 v[148:151], v236 offset:32768
v_mfma_f32_16x16x32_bf16 v[40:43], v[216:219], v[220:223], v[40:43]
s_waitcnt lgkmcnt(14)
ds_read_b64_tr_b16 v[176:177], v240 offset:14336
v_mfma_f32_16x16x32_bf16 v[40:43], v[136:139], v[132:135], v[40:43]
ds_read_b64_tr_b16 v[178:179], v240 offset:15360
v_mfma_f32_16x16x32_bf16 v[24:27], v[136:139], v[152:155], v[24:27]
ds_read_b128 v[188:191], v236 offset:33024
v_mfma_f32_16x16x32_bf16 v[24:27], v[216:219], v[132:135], v[24:27]
ds_read_b64_tr_b16 v[200:201], v240 offset:16384
v_mfma_f32_16x16x32_bf16 v[24:27], v[228:231], v[220:223], v[24:27]
ds_read_b64_tr_b16 v[202:203], v240 offset:17408
v_mfma_f32_16x16x32_bf16 v[8:11], v[228:231], v[132:135], v[8:11]
ds_read_b128 v[196:199], v236 offset:33280
v_mfma_f32_16x16x32_bf16 v[8:11], v[216:219], v[152:155], v[8:11]
ds_read_b128 v[168:171], v236 offset:33536
v_mfma_f32_16x16x32_bf16 v[8:11], v[136:139], v[128:131], v[8:11]
s_waitcnt lgkmcnt(14)
ds_read_b128 v[184:187], v236 offset:33792
v_mfma_f32_16x16x32_bf16 v[4:7], v[140:143], v[128:131], v[4:7]
ds_read_b64_tr_b16 v[212:213], v242 offset:16384
v_mfma_f32_16x16x32_bf16 v[4:7], v[144:147], v[152:155], v[4:7]
ds_read_b64_tr_b16 v[214:215], v242 offset:17408
v_mfma_f32_16x16x32_bf16 v[4:7], v[164:167], v[132:135], v[4:7]
ds_read_b64_tr_b16 v[160:161], v242 offset:14336
v_mfma_f32_16x16x32_bf16 v[20:23], v[164:167], v[220:223], v[20:23]
ds_read_b64_tr_b16 v[162:163], v242 offset:15360
v_mfma_f32_16x16x32_bf16 v[20:23], v[144:147], v[132:135], v[20:23]
ds_read_b64_tr_b16 v[248:249], v242 offset:12288
v_mfma_f32_16x16x32_bf16 v[20:23], v[140:143], v[152:155], v[20:23]
ds_read_b64_tr_b16 v[250:251], v242 offset:13312
v_mfma_f32_16x16x32_bf16 v[36:39], v[140:143], v[132:135], v[36:39]
ds_read_b64_tr_b16 v[180:181], v241 offset:12288
v_mfma_f32_16x16x32_bf16 v[36:39], v[144:147], v[220:223], v[36:39]
ds_read_b64_tr_b16 v[182:183], v241 offset:13312
v_mfma_f32_16x16x32_bf16 v[36:39], v[164:167], v[224:227], v[36:39]
ds_read_b64_tr_b16 v[208:209], v241 offset:14336
v_mfma_f32_16x16x32_bf16 v[44:47], v[204:207], v[224:227], v[44:47]
s_waitcnt lgkmcnt(14)
ds_read_b64_tr_b16 v[210:211], v241 offset:15360
v_mfma_f32_16x16x32_bf16 v[44:47], v[156:159], v[220:223], v[44:47]
ds_read_b64_tr_b16 v[232:233], v241 offset:16384
v_mfma_f32_16x16x32_bf16 v[44:47], v[172:175], v[132:135], v[44:47]
ds_read_b64_tr_b16 v[234:235], v241 offset:17408
v_mfma_f32_16x16x32_bf16 v[28:31], v[172:175], v[152:155], v[28:31]
ds_read_b64_tr_b16 v[228:229], v243 offset:16384
v_mfma_f32_16x16x32_bf16 v[28:31], v[156:159], v[132:135], v[28:31]
ds_read_b64_tr_b16 v[230:231], v243 offset:17408
v_mfma_f32_16x16x32_bf16 v[28:31], v[204:207], v[220:223], v[28:31]
ds_read_b64_tr_b16 v[216:217], v243 offset:14336
v_mfma_f32_16x16x32_bf16 v[12:15], v[204:207], v[132:135], v[12:15]
ds_read_b64_tr_b16 v[218:219], v243 offset:15360
v_mfma_f32_16x16x32_bf16 v[12:15], v[156:159], v[152:155], v[12:15]
ds_read_b64_tr_b16 v[136:137], v243 offset:12288
v_mfma_f32_16x16x32_bf16 v[12:15], v[172:175], v[128:131], v[12:15]
ds_read_b64_tr_b16 v[138:139], v243 offset:13312
v_mfma_f32_16x16x32_bf16 v[0:3], v[192:195], v[148:151], v[0:3]
v_mfma_f32_16x16x32_bf16 v[0:3], v[176:179], v[188:191], v[0:3]
s_waitcnt lgkmcnt(14)
v_mfma_f32_16x16x32_bf16 v[0:3], v[200:203], v[196:199], v[0:3]
v_mfma_f32_16x16x32_bf16 v[16:19], v[200:203], v[168:171], v[16:19]
v_mfma_f32_16x16x32_bf16 v[16:19], v[176:179], v[196:199], v[16:19]
v_mfma_f32_16x16x32_bf16 v[16:19], v[192:195], v[188:191], v[16:19]
v_mfma_f32_16x16x32_bf16 v[32:35], v[192:195], v[196:199], v[32:35]
v_mfma_f32_16x16x32_bf16 v[32:35], v[176:179], v[168:171], v[32:35]
s_barrier
ds_read_b64_tr_b16 v[140:141], v240 offset:18432
v_mfma_f32_16x16x32_bf16 v[32:35], v[200:203], v[184:187], v[32:35]
ds_read_b64_tr_b16 v[142:143], v240 offset:19456
v_mfma_f32_16x16x32_bf16 v[40:43], v[212:215], v[184:187], v[40:43]
ds_read_b128 v[144:147], v238 offset:32768
v_mfma_f32_16x16x32_bf16 v[40:43], v[160:163], v[168:171], v[40:43]
s_waitcnt lgkmcnt(14)
ds_read_b64_tr_b16 v[164:165], v240 offset:20480
v_mfma_f32_16x16x32_bf16 v[40:43], v[248:251], v[196:199], v[40:43]
ds_read_b64_tr_b16 v[166:167], v240 offset:21504
v_mfma_f32_16x16x32_bf16 v[24:27], v[248:251], v[188:191], v[24:27]
ds_read_b128 v[224:227], v238 offset:33024
v_mfma_f32_16x16x32_bf16 v[24:27], v[160:163], v[196:199], v[24:27]
ds_read_b64_tr_b16 v[220:221], v240 offset:22528
v_mfma_f32_16x16x32_bf16 v[24:27], v[212:215], v[168:171], v[24:27]
ds_read_b64_tr_b16 v[222:223], v240 offset:23552
v_mfma_f32_16x16x32_bf16 v[8:11], v[212:215], v[196:199], v[8:11]
ds_read_b128 v[204:207], v238 offset:33280
v_mfma_f32_16x16x32_bf16 v[8:11], v[160:163], v[188:191], v[8:11]
ds_read_b64_tr_b16 v[132:133], v242 offset:22528
v_mfma_f32_16x16x32_bf16 v[8:11], v[248:251], v[148:151], v[8:11]
s_waitcnt lgkmcnt(14)
ds_read_b64_tr_b16 v[134:135], v242 offset:23552
v_mfma_f32_16x16x32_bf16 v[4:7], v[180:183], v[148:151], v[4:7]
ds_read_b64_tr_b16 v[156:157], v242 offset:20480
v_mfma_f32_16x16x32_bf16 v[4:7], v[208:211], v[188:191], v[4:7]
ds_read_b64_tr_b16 v[158:159], v242 offset:21504
v_mfma_f32_16x16x32_bf16 v[4:7], v[232:235], v[196:199], v[4:7]
ds_read_b64_tr_b16 v[152:153], v242 offset:18432
v_mfma_f32_16x16x32_bf16 v[20:23], v[232:235], v[168:171], v[20:23]
ds_read_b64_tr_b16 v[154:155], v242 offset:19456
v_mfma_f32_16x16x32_bf16 v[20:23], v[208:211], v[196:199], v[20:23]
ds_read_b64_tr_b16 v[172:173], v241 offset:18432
v_mfma_f32_16x16x32_bf16 v[20:23], v[180:183], v[188:191], v[20:23]
ds_read_b64_tr_b16 v[174:175], v241 offset:19456
v_mfma_f32_16x16x32_bf16 v[36:39], v[180:183], v[196:199], v[36:39]
ds_read_b64_tr_b16 v[128:129], v241 offset:20480
v_mfma_f32_16x16x32_bf16 v[36:39], v[208:211], v[168:171], v[36:39]
ds_read_b64_tr_b16 v[130:131], v241 offset:21504
v_mfma_f32_16x16x32_bf16 v[36:39], v[232:235], v[184:187], v[36:39]
ds_read_b64_tr_b16 v[192:193], v241 offset:22528
v_mfma_f32_16x16x32_bf16 v[44:47], v[228:231], v[184:187], v[44:47]
s_waitcnt lgkmcnt(14)
ds_read_b64_tr_b16 v[194:195], v241 offset:23552
v_mfma_f32_16x16x32_bf16 v[44:47], v[216:219], v[168:171], v[44:47]
ds_read_b64_tr_b16 v[176:177], v243 offset:22528
v_mfma_f32_16x16x32_bf16 v[44:47], v[136:139], v[196:199], v[44:47]
ds_read_b64_tr_b16 v[178:179], v243 offset:23552
v_mfma_f32_16x16x32_bf16 v[28:31], v[136:139], v[188:191], v[28:31]
ds_read_b64_tr_b16 v[200:201], v243 offset:20480
v_mfma_f32_16x16x32_bf16 v[28:31], v[216:219], v[196:199], v[28:31]
ds_read_b64_tr_b16 v[202:203], v243 offset:21504
v_mfma_f32_16x16x32_bf16 v[28:31], v[228:231], v[168:171], v[28:31]
ds_read_b64_tr_b16 v[212:213], v243 offset:18432
v_mfma_f32_16x16x32_bf16 v[12:15], v[228:231], v[196:199], v[12:15]
ds_read_b64_tr_b16 v[214:215], v243 offset:19456
v_mfma_f32_16x16x32_bf16 v[12:15], v[216:219], v[188:191], v[12:15]
ds_read_b128 v[160:163], v238 offset:33536
v_mfma_f32_16x16x32_bf16 v[12:15], v[136:139], v[148:151], v[12:15]
ds_read_b128 v[248:251], v238 offset:33792
v_mfma_f32_16x16x32_bf16 v[0:3], v[140:143], v[144:147], v[0:3]
ds_read_b64_tr_b16 v[180:181], v240 offset:0
v_mfma_f32_16x16x32_bf16 v[0:3], v[164:167], v[224:227], v[0:3]
s_waitcnt lgkmcnt(14)
ds_read_b64_tr_b16 v[182:183], v240 offset:1024
v_mfma_f32_16x16x32_bf16 v[0:3], v[220:223], v[204:207], v[0:3]
ds_read_b128 v[208:211], v236 offset:768
v_mfma_f32_16x16x32_bf16 v[8:11], v[132:135], v[204:207], v[8:11]
ds_read_b64_tr_b16 v[232:233], v240 offset:2048
v_mfma_f32_16x16x32_bf16 v[8:11], v[156:159], v[224:227], v[8:11]
ds_read_b64_tr_b16 v[234:235], v240 offset:3072
v_mfma_f32_16x16x32_bf16 v[8:11], v[152:155], v[144:147], v[8:11]
s_waitcnt lgkmcnt(14)
ds_read_b128 v[184:187], v236 offset:1024
v_mfma_f32_16x16x32_bf16 v[4:7], v[172:175], v[144:147], v[4:7]
ds_read_b64_tr_b16 v[168:169], v240 offset:4096
v_mfma_f32_16x16x32_bf16 v[4:7], v[128:131], v[224:227], v[4:7]
s_waitcnt lgkmcnt(14)
ds_read_b64_tr_b16 v[170:171], v240 offset:5120
v_mfma_f32_16x16x32_bf16 v[4:7], v[192:195], v[204:207], v[4:7]
s_waitcnt lgkmcnt(14)
ds_read_b128 v[228:231], v236 offset:1280
v_fma_f32 v0, v0, s32, v246
v_mfma_f32_16x16x32_bf16 v[12:15], v[176:179], v[204:207], v[12:15]
s_waitcnt lgkmcnt(13)
v_exp_f32 v0, v0
v_mfma_f32_16x16x32_bf16 v[12:15], v[200:203], v[224:227], v[12:15]
s_waitcnt lgkmcnt(11)
ds_read_b128 v[196:199], v236 offset:1536
v_fma_f32 v0, v0, s36, s36 clamp
v_mfma_f32_16x16x32_bf16 v[12:15], v[212:215], v[144:147], v[12:15]
ds_read_b128 v[216:219], v236 offset:1792
v_fma_f32 v8, v8, s34, v252
v_mfma_f32_16x16x32_bf16 v[16:19], v[140:143], v[224:227], v[16:19]
v_exp_f32 v8, v8
v_mfma_f32_16x16x32_bf16 v[16:19], v[164:167], v[204:207], v[16:19]
s_waitcnt lgkmcnt(12)
ds_read_b128 v[188:191], v237 offset:0
v_fma_f32 v8, v8, v0, v0
v_mfma_f32_16x16x32_bf16 v[16:19], v[220:223], v[160:163], v[16:19]
v_rcp_f32 v8, v8
v_mfma_f32_16x16x32_bf16 v[24:27], v[132:135], v[160:163], v[24:27]
ds_read_b128 v[136:139], v237 offset:256
v_add_f32 v0, s38, v0
v_mfma_f32_16x16x32_bf16 v[24:27], v[156:159], v[204:207], v[24:27]
ds_read_b64_tr_b16 v[148:149], v242 offset:4096
v_mul_f32 v8, v0, v8
v_mfma_f32_16x16x32_bf16 v[24:27], v[152:155], v[224:227], v[24:27]
ds_read_b64_tr_b16 v[150:151], v242 offset:5120
v_fma_f32 v1, v1, s32, v246
v_mfma_f32_16x16x32_bf16 v[20:23], v[172:175], v[224:227], v[20:23]
v_exp_f32 v1, v1
v_mfma_f32_16x16x32_bf16 v[20:23], v[128:131], v[204:207], v[20:23]
ds_read_b64_tr_b16 v[144:145], v242 offset:2048
v_fma_f32 v1, v1, s36, s36 clamp
v_mfma_f32_16x16x32_bf16 v[20:23], v[192:195], v[160:163], v[20:23]
ds_read_b64_tr_b16 v[146:147], v242 offset:3072
v_fma_f32 v9, v9, s34, v252
v_mfma_f32_16x16x32_bf16 v[28:31], v[176:179], v[160:163], v[28:31]
v_exp_f32 v9, v9
v_mfma_f32_16x16x32_bf16 v[28:31], v[200:203], v[204:207], v[28:31]
v_fma_f32 v9, v9, v1, v1
v_add_f32 v1, s38, v1
v_mfma_f32_16x16x32_bf16 v[28:31], v[212:215], v[224:227], v[28:31]
v_rcp_f32 v9, v9
v_mfma_f32_16x16x32_bf16 v[32:35], v[140:143], v[204:207], v[32:35]
ds_read_b64_tr_b16 v[224:225], v242 offset:0
v_mul_f32 v9, v1, v9
v_mfma_f32_16x16x32_bf16 v[32:35], v[164:167], v[160:163], v[32:35]
s_waitcnt lgkmcnt(14)
ds_read_b64_tr_b16 v[226:227], v242 offset:1024
v_fma_f32 v2, v2, s32, v246
v_mfma_f32_16x16x32_bf16 v[32:35], v[220:223], v[248:251], v[32:35]
v_exp_f32 v2, v2
v_mfma_f32_16x16x32_bf16 v[40:43], v[132:135], v[248:251], v[40:43]
ds_read_b64_tr_b16 v[140:141], v241 offset:0
v_fma_f32 v2, v2, s36, s36 clamp
v_mfma_f32_16x16x32_bf16 v[40:43], v[156:159], v[160:163], v[40:43]
ds_read_b64_tr_b16 v[142:143], v241 offset:1024
v_fma_f32 v10, v10, s34, v252
v_mfma_f32_16x16x32_bf16 v[40:43], v[152:155], v[204:207], v[40:43]
L_pad4:
s_cmp_eq_u32 s79, 1
s_cbranch_scc1 L_lret4
v_exp_f32 v10, v10
v_mfma_f32_16x16x32_bf16 v[36:39], v[172:175], v[204:207], v[36:39]
ds_read_b64_tr_b16 v[164:165], v241 offset:2048
v_fma_f32 v10, v10, v2, v2
v_mfma_f32_16x16x32_bf16 v[36:39], v[128:131], v[160:163], v[36:39]
v_rcp_f32 v10, v10
v_mfma_f32_16x16x32_bf16 v[36:39], v[192:195], v[248:251], v[36:39]
ds_read_b64_tr_b16 v[166:167], v241 offset:3072
v_add_f32 v2, s38, v2
v_mfma_f32_16x16x32_bf16 v[44:47], v[176:179], v[248:251], v[44:47]
ds_read_b64_tr_b16 v[220:221], v241 offset:4096
v_mul_f32 v10, v2, v10
v_mfma_f32_16x16x32_bf16 v[44:47], v[200:203], v[160:163], v[44:47]
ds_read_b64_tr_b16 v[222:223], v241 offset:5120
v_fma_f32 v3, v3, s32, v246
v_mfma_f32_16x16x32_bf16 v[44:47], v[212:215], v[204:207], v[44:47]
v_exp_f32 v3, v3
v_mfma_f32_16x16x32_bf16 v[48:51], v[180:183], v[208:211], v[48:51]
s_waitcnt lgkmcnt(14)
ds_read_b64_tr_b16 v[132:133], v243 offset:4096
v_fma_f32 v3, v3, s36, s36 clamp
v_mfma_f32_16x16x32_bf16 v[48:51], v[232:235], v[184:187], v[48:51]
ds_read_b64_tr_b16 v[134:135], v243 offset:5120
v_fma_f32 v11, v11, s34, v252
v_mfma_f32_16x16x32_bf16 v[48:51], v[168:171], v[228:231], v[48:51]
v_exp_f32 v11, v11
v_mfma_f32_16x16x32_bf16 v[64:67], v[168:171], v[196:199], v[64:67]
ds_read_b64_tr_b16 v[156:157], v243 offset:2048
v_fma_f32 v11, v11, v3, v3
v_mfma_f32_16x16x32_bf16 v[64:67], v[232:235], v[228:231], v[64:67]
v_rcp_f32 v11, v11
v_mfma_f32_16x16x32_bf16 v[64:67], v[180:183], v[184:187], v[64:67]
ds_read_b64_tr_b16 v[158:159], v243 offset:3072
v_add_f32 v3, s38, v3
v_mfma_f32_16x16x32_bf16 v[80:83], v[180:183], v[228:231], v[80:83]
ds_read_b64_tr_b16 v[152:153], v243 offset:0
v_mul_f32 v11, v3, v11
v_mfma_f32_16x16x32_bf16 v[80:83], v[232:235], v[196:199], v[80:83]
ds_read_b64_tr_b16 v[154:155], v243 offset:1024
v_cvt_pk_bf16_f32 v0, v8, v9
v_mfma_f32_16x16x32_bf16 v[80:83], v[168:171], v[216:219], v[80:83]
s_waitcnt lgkmcnt(14)
v_cvt_pk_bf16_f32 v1, v10, v11
v_fma_f32 v4, v4, s32, v246
v_mfma_f32_16x16x32_bf16 v[96:99], v[168:171], v[188:191], v[96:99]
v_exp_f32 v4, v4
v_mfma_f32_16x16x32_bf16 v[96:99], v[232:235], v[216:219], v[96:99]
v_fma_f32 v4, v4, s36, s36 clamp
v_fma_f32 v12, v12, s34, v252
v_mfma_f32_16x16x32_bf16 v[96:99], v[180:183], v[196:199], v[96:99]
v_exp_f32 v12, v12
v_mfma_f32_16x16x32_bf16 v[112:115], v[180:183], v[216:219], v[112:115]
ds_read_b64_tr_b16 v[172:173], v240 offset:6144
v_fma_f32 v12, v12, v4, v4
v_mfma_f32_16x16x32_bf16 v[112:115], v[232:235], v[188:191], v[112:115]
v_rcp_f32 v12, v12
v_mfma_f32_16x16x32_bf16 v[112:115], v[168:171], v[136:139], v[112:115]
ds_read_b64_tr_b16 v[174:175], v240 offset:7168
v_add_f32 v4, s38, v4
v_mfma_f32_16x16x32_bf16 v[120:123], v[148:151], v[136:139], v[120:123]
ds_read_b128 v[128:131], v238 offset:768
v_mul_f32 v12, v4, v12
v_mfma_f32_16x16x32_bf16 v[120:123], v[144:147], v[188:191], v[120:123]
s_waitcnt lgkmcnt(14)
ds_read_b64_tr_b16 v[192:193], v240 offset:8192
v_fma_f32 v5, v5, s32, v246
v_mfma_f32_16x16x32_bf16 v[120:123], v[224:227], v[216:219], v[120:123]
v_exp_f32 v5, v5
v_mfma_f32_16x16x32_bf16 v[104:107], v[224:227], v[196:199], v[104:107]
ds_read_b64_tr_b16 v[194:195], v240 offset:9216
v_fma_f32 v5, v5, s36, s36 clamp
v_mfma_f32_16x16x32_bf16 v[104:107], v[144:147], v[216:219], v[104:107]
ds_read_b128 v[176:179], v238 offset:1024
v_fma_f32 v13, v13, s34, v252
v_mfma_f32_16x16x32_bf16 v[104:107], v[148:151], v[188:191], v[104:107]
v_exp_f32 v13, v13
v_mfma_f32_16x16x32_bf16 v[88:91], v[148:151], v[216:219], v[88:91]
ds_read_b64_tr_b16 v[248:249], v240 offset:10240
v_fma_f32 v13, v13, v5, v5
v_mfma_f32_16x16x32_bf16 v[88:91], v[144:147], v[196:199], v[88:91]
v_rcp_f32 v13, v13
v_mfma_f32_16x16x32_bf16 v[88:91], v[224:227], v[228:231], v[88:91]
ds_read_b64_tr_b16 v[250:251], v240 offset:11264
v_add_f32 v5, s38, v5
v_mfma_f32_16x16x32_bf16 v[72:75], v[224:227], v[184:187], v[72:75]
ds_read_b128 v[200:203], v238 offset:1280
v_mul_f32 v13, v5, v13
v_mfma_f32_16x16x32_bf16 v[72:75], v[144:147], v[228:231], v[72:75]
ds_read_b128 v[160:163], v238 offset:1536
v_fma_f32 v6, v6, s32, v246
v_mfma_f32_16x16x32_bf16 v[72:75], v[148:151], v[196:199], v[72:75]
v_exp_f32 v6, v6
v_mfma_f32_16x16x32_bf16 v[56:59], v[148:151], v[228:231], v[56:59]
ds_read_b128 v[212:215], v238 offset:1792
v_fma_f32 v6, v6, s36, s36 clamp
v_mfma_f32_16x16x32_bf16 v[56:59], v[144:147], v[184:187], v[56:59]
ds_read_b128 v[204:207], v239 offset:0
v_fma_f32 v14, v14, s34, v252
v_mfma_f32_16x16x32_bf16 v[56:59], v[224:227], v[208:211], v[56:59]
s_waitcnt lgkmcnt(14)
v_exp_f32 v14, v14
v_mfma_f32_16x16x32_bf16 v[52:55], v[140:143], v[208:211], v[52:55]
ds_read_b128 v[180:183], v239 offset:256
v_fma_f32 v14, v14, v6, v6
v_mfma_f32_16x16x32_bf16 v[52:55], v[164:167], v[184:187], v[52:55]
v_rcp_f32 v14, v14
v_mfma_f32_16x16x32_bf16 v[52:55], v[220:223], v[228:231], v[52:55]
ds_read_b64_tr_b16 v[232:233], v242 offset:10240
v_add_f32 v6, s38, v6
v_mfma_f32_16x16x32_bf16 v[68:71], v[220:223], v[196:199], v[68:71]
ds_read_b64_tr_b16 v[234:235], v242 offset:11264
v_mul_f32 v14, v6, v14
v_mfma_f32_16x16x32_bf16 v[68:71], v[164:167], v[228:231], v[68:71]
ds_read_b64_tr_b16 v[168:169], v242 offset:8192
v_fma_f32 v7, v7, s32, v246
v_mfma_f32_16x16x32_bf16 v[68:71], v[140:143], v[184:187], v[68:71]
v_exp_f32 v7, v7
v_mfma_f32_16x16x32_bf16 v[84:87], v[140:143], v[228:231], v[84:87]
ds_read_b64_tr_b16 v[170:171], v242 offset:9216
v_fma_f32 v7, v7, s36, s36 clamp
v_mfma_f32_16x16x32_bf16 v[84:87], v[164:167], v[196:199], v[84:87]
ds_read_b64_tr_b16 v[148:149], v242 offset:6144
v_fma_f32 v15, v15, s34, v252
v_mfma_f32_16x16x32_bf16 v[84:87], v[220:223], v[216:219], v[84:87]
v_exp_f32 v15, v15
v_mfma_f32_16x16x32_bf16 v[100:103], v[220:223], v[188:191], v[100:103]
ds_read_b64_tr_b16 v[150:151], v242 offset:7168
v_fma_f32 v15, v15, v7, v7
v_mfma_f32_16x16x32_bf16 v[100:103], v[164:167], v[216:219], v[100:103]
v_rcp_f32 v15, v15
v_mfma_f32_16x16x32_bf16 v[100:103], v[140:143], v[196:199], v[100:103]
v_add_f32 v7, s38, v7
v_mul_f32 v15, v7, v15
v_mfma_f32_16x16x32_bf16 v[116:119], v[140:143], v[216:219], v[116:119]
ds_read_b64_tr_b16 v[144:145], v241 offset:6144
v_cvt_pk_bf16_f32 v2, v12, v13
v_mfma_f32_16x16x32_bf16 v[116:119], v[164:167], v[188:191], v[116:119]
ds_read_b64_tr_b16 v[146:147], v241 offset:7168
v_cvt_pk_bf16_f32 v3, v14, v15
v_mfma_f32_16x16x32_bf16 v[116:119], v[220:223], v[136:139], v[116:119]
ds_read_b64_tr_b16 v[224:225], v241 offset:8192
v_fma_f32 v16, v16, s32, v246
v_mfma_f32_16x16x32_bf16 v[124:127], v[132:135], v[136:139], v[124:127]
v_permlane16_swap_b32 v0, v2
v_mfma_f32_16x16x32_bf16 v[124:127], v[156:159], v[188:191], v[124:127]
s_waitcnt lgkmcnt(14)
v_permlane16_swap_b32 v1, v3
v_mfma_f32_16x16x32_bf16 v[124:127], v[152:155], v[216:219], v[124:127]
buffer_store_dwordx4 v[0:3], v244, s[20:23], 0 offen offset:0 sc0 sc1 nt
v_mfma_f32_16x16x32_bf16 v[108:111], v[152:155], v[196:199], v[108:111]
v_exp_f32 v16, v16
v_mfma_f32_16x16x32_bf16 v[108:111], v[156:159], v[216:219], v[108:111]
ds_read_b64_tr_b16 v[226:227], v241 offset:9216
v_fma_f32 v16, v16, s36, s36 clamp
v_mfma_f32_16x16x32_bf16 v[108:111], v[132:135], v[188:191], v[108:111]
ds_read_b64_tr_b16 v[140:141], v241 offset:10240
v_fma_f32 v24, v24, s34, v252
v_mfma_f32_16x16x32_bf16 v[92:95], v[132:135], v[216:219], v[92:95]
v_exp_f32 v24, v24
v_mfma_f32_16x16x32_bf16 v[92:95], v[156:159], v[196:199], v[92:95]
ds_read_b64_tr_b16 v[142:143], v241 offset:11264
v_fma_f32 v24, v24, v16, v16
v_mfma_f32_16x16x32_bf16 v[92:95], v[152:155], v[228:231], v[92:95]
v_rcp_f32 v24, v24
v_mfma_f32_16x16x32_bf16 v[76:79], v[152:155], v[184:187], v[76:79]
v_add_f32 v16, s38, v16
v_mul_f32 v24, v16, v24
v_mfma_f32_16x16x32_bf16 v[76:79], v[156:159], v[228:231], v[76:79]
v_fma_f32 v17, v17, s32, v246
v_fma_f32 v25, v25, s34, v252
v_mfma_f32_16x16x32_bf16 v[76:79], v[132:135], v[196:199], v[76:79]
v_exp_f32 v17, v17
v_mfma_f32_16x16x32_bf16 v[60:63], v[132:135], v[228:231], v[60:63]
v_exp_f32 v25, v25
v_mfma_f32_16x16x32_bf16 v[60:63], v[156:159], v[184:187], v[60:63]
ds_read_b64_tr_b16 v[164:165], v243 offset:10240
v_fma_f32 v17, v17, s36, s36 clamp
v_mfma_f32_16x16x32_bf16 v[60:63], v[152:155], v[208:211], v[60:63]
ds_read_b64_tr_b16 v[166:167], v243 offset:11264
v_fma_f32 v25, v25, v17, v17
v_mfma_f32_16x16x32_bf16 v[48:51], v[172:175], v[128:131], v[48:51]
v_rcp_f32 v25, v25
v_mfma_f32_16x16x32_bf16 v[48:51], v[192:195], v[176:179], v[48:51]
s_waitcnt lgkmcnt(14)
ds_read_b64_tr_b16 v[220:221], v243 offset:8192
v_add_f32 v17, s38, v17
v_mfma_f32_16x16x32_bf16 v[48:51], v[248:251], v[200:203], v[48:51]
ds_read_b64_tr_b16 v[222:223], v243 offset:9216
v_mul_f32 v25, v17, v25
v_mfma_f32_16x16x32_bf16 v[64:67], v[248:251], v[160:163], v[64:67]
ds_read_b64_tr_b16 v[136:137], v243 offset:6144
v_fma_f32 v18, v18, s32, v246
v_mfma_f32_16x16x32_bf16 v[64:67], v[192:195], v[200:203], v[64:67]
v_exp_f32 v18, v18
v_mfma_f32_16x16x32_bf16 v[64:67], v[172:175], v[176:179], v[64:67]
ds_read_b64_tr_b16 v[138:139], v243 offset:7168
v_fma_f32 v18, v18, s36, s36 clamp
v_mfma_f32_16x16x32_bf16 v[80:83], v[172:175], v[200:203], v[80:83]
v_fma_f32 v26, v26, s34, v252
v_fma_f32 v19, v19, s32, v246
v_mfma_f32_16x16x32_bf16 v[80:83], v[192:195], v[160:163], v[80:83]
v_exp_f32 v26, v26
v_mfma_f32_16x16x32_bf16 v[80:83], v[248:251], v[212:215], v[80:83]
v_exp_f32 v19, v19
v_mfma_f32_16x16x32_bf16 v[96:99], v[248:251], v[204:207], v[96:99]
v_fma_f32 v26, v26, v18, v18
v_add_f32 v18, s38, v18
v_mfma_f32_16x16x32_bf16 v[96:99], v[192:195], v[212:215], v[96:99]
v_rcp_f32 v26, v26
v_mfma_f32_16x16x32_bf16 v[96:99], v[172:175], v[160:163], v[96:99]
v_mul_f32 v26, v18, v26
v_fma_f32 v19, v19, s36, s36 clamp
v_mfma_f32_16x16x32_bf16 v[112:115], v[172:175], v[212:215], v[112:115]
ds_read_b64_tr_b16 v[188:189], v240 offset:12288
v_fma_f32 v27, v27, s34, v252
v_mfma_f32_16x16x32_bf16 v[112:115], v[192:195], v[204:207], v[112:115]
v_exp_f32 v27, v27
v_mfma_f32_16x16x32_bf16 v[112:115], v[248:251], v[180:183], v[112:115]
s_waitcnt lgkmcnt(14)
ds_read_b64_tr_b16 v[190:191], v240 offset:13312
v_fma_f32 v27, v27, v19, v19
v_mfma_f32_16x16x32_bf16 v[120:123], v[232:235], v[180:183], v[120:123]
v_rcp_f32 v27, v27
v_mfma_f32_16x16x32_bf16 v[120:123], v[168:171], v[204:207], v[120:123]
s_waitcnt lgkmcnt(14)
ds_read_b128 v[216:219], v236 offset:33536
v_add_f32 v19, s38, v19
v_mfma_f32_16x16x32_bf16 v[120:123], v[148:151], v[212:215], v[120:123]
ds_read_b64_tr_b16 v[196:197], v240 offset:14336
v_mul_f32 v27, v19, v27
v_mfma_f32_16x16x32_bf16 v[104:107], v[148:151], v[160:163], v[104:107]
ds_read_b64_tr_b16 v[198:199], v240 offset:15360
v_cvt_pk_bf16_f32 v16, v24, v25
v_mfma_f32_16x16x32_bf16 v[104:107], v[168:171], v[212:215], v[104:107]
ds_read_b128 v[132:135], v236 offset:33792
v_cvt_pk_bf16_f32 v17, v26, v27
v_mfma_f32_16x16x32_bf16 v[104:107], v[232:235], v[204:207], v[104:107]
ds_read_b64_tr_b16 v[228:229], v240 offset:16384
v_fma_f32 v20, v20, s32, v246
v_mfma_f32_16x16x32_bf16 v[88:91], v[232:235], v[212:215], v[88:91]
v_exp_f32 v20, v20
v_mfma_f32_16x16x32_bf16 v[88:91], v[168:171], v[160:163], v[88:91]
ds_read_b64_tr_b16 v[230:231], v240 offset:17408
v_fma_f32 v20, v20, s36, s36 clamp
v_mfma_f32_16x16x32_bf16 v[88:91], v[148:151], v[200:203], v[88:91]
ds_read_b128 v[156:159], v236 offset:34048
v_fma_f32 v28, v28, s34, v252
v_mfma_f32_16x16x32_bf16 v[72:75], v[148:151], v[176:179], v[72:75]
v_exp_f32 v28, v28
v_mfma_f32_16x16x32_bf16 v[72:75], v[168:171], v[200:203], v[72:75]
ds_read_b128 v[184:187], v236 offset:34304
v_fma_f32 v28, v28, v20, v20
v_mfma_f32_16x16x32_bf16 v[72:75], v[232:235], v[160:163], v[72:75]
v_rcp_f32 v28, v28
v_mfma_f32_16x16x32_bf16 v[56:59], v[232:235], v[200:203], v[56:59]
ds_read_b128 v[152:155], v236 offset:34560
v_add_f32 v20, s38, v20
v_mfma_f32_16x16x32_bf16 v[56:59], v[168:171], v[176:179], v[56:59]
ds_read_b128 v[208:211], v237 offset:32768
v_mul_f32 v28, v20, v28
v_mfma_f32_16x16x32_bf16 v[56:59], v[148:151], v[128:131], v[56:59]
s_waitcnt lgkmcnt(14)
ds_read_b128 v[172:175], v237 offset:33024
v_fma_f32 v21, v21, s32, v246
v_mfma_f32_16x16x32_bf16 v[52:55], v[144:147], v[128:131], v[52:55]
v_exp_f32 v21, v21
v_mfma_f32_16x16x32_bf16 v[52:55], v[224:227], v[176:179], v[52:55]
ds_read_b64_tr_b16 v[192:193], v242 offset:16384
v_fma_f32 v21, v21, s36, s36 clamp
v_mfma_f32_16x16x32_bf16 v[52:55], v[140:143], v[200:203], v[52:55]
ds_read_b64_tr_b16 v[194:195], v242 offset:17408
v_fma_f32 v29, v29, s34, v252
v_mfma_f32_16x16x32_bf16 v[68:71], v[140:143], v[160:163], v[68:71]
v_exp_f32 v29, v29
v_mfma_f32_16x16x32_bf16 v[68:71], v[224:227], v[200:203], v[68:71]
ds_read_b64_tr_b16 v[248:249], v242 offset:14336
v_fma_f32 v29, v29, v21, v21
v_mfma_f32_16x16x32_bf16 v[68:71], v[144:147], v[176:179], v[68:71]
v_rcp_f32 v29, v29
v_mfma_f32_16x16x32_bf16 v[84:87], v[144:147], v[200:203], v[84:87]
ds_read_b64_tr_b16 v[250:251], v242 offset:15360
v_add_f32 v21, s38, v21
v_mfma_f32_16x16x32_bf16 v[84:87], v[224:227], v[160:163], v[84:87]
ds_read_b64_tr_b16 v[232:233], v242 offset:12288
v_mul_f32 v29, v21, v29
v_mfma_f32_16x16x32_bf16 v[84:87], v[140:143], v[212:215], v[84:87]
ds_read_b64_tr_b16 v[234:235], v242 offset:13312
v_fma_f32 v22, v22, s32, v246
v_mfma_f32_16x16x32_bf16 v[100:103], v[140:143], v[204:207], v[100:103]
v_exp_f32 v22, v22
v_mfma_f32_16x16x32_bf16 v[100:103], v[224:227], v[212:215], v[100:103]
v_fma_f32 v22, v22, s36, s36 clamp
v_fma_f32 v30, v30, s34, v252
v_mfma_f32_16x16x32_bf16 v[100:103], v[144:147], v[160:163], v[100:103]
v_exp_f32 v30, v30
v_mfma_f32_16x16x32_bf16 v[116:119], v[144:147], v[212:215], v[116:119]
ds_read_b64_tr_b16 v[168:169], v241 offset:12288
v_fma_f32 v30, v30, v22, v22
v_mfma_f32_16x16x32_bf16 v[116:119], v[224:227], v[204:207], v[116:119]
v_rcp_f32 v30, v30
v_mfma_f32_16x16x32_bf16 v[116:119], v[140:143], v[180:183], v[116:119]
ds_read_b64_tr_b16 v[170:171], v241 offset:13312
v_add_f32 v22, s38, v22
v_mfma_f32_16x16x32_bf16 v[124:127], v[164:167], v[180:183], v[124:127]
ds_read_b64_tr_b16 v[148:149], v241 offset:14336
v_mul_f32 v30, v22, v30
v_mfma_f32_16x16x32_bf16 v[124:127], v[220:223], v[204:207], v[124:127]
s_waitcnt lgkmcnt(14)
ds_read_b64_tr_b16 v[150:151], v241 offset:15360
v_fma_f32 v23, v23, s32, v246
v_mfma_f32_16x16x32_bf16 v[124:127], v[136:139], v[212:215], v[124:127]
v_exp_f32 v23, v23
v_mfma_f32_16x16x32_bf16 v[108:111], v[136:139], v[160:163], v[108:111]
ds_read_b64_tr_b16 v[144:145], v241 offset:16384
v_fma_f32 v23, v23, s36, s36 clamp
v_mfma_f32_16x16x32_bf16 v[108:111], v[220:223], v[212:215], v[108:111]
ds_read_b64_tr_b16 v[146:147], v241 offset:17408
v_fma_f32 v31, v31, s34, v252
v_mfma_f32_16x16x32_bf16 v[108:111], v[164:167], v[204:207], v[108:111]
v_exp_f32 v31, v31
v_mfma_f32_16x16x32_bf16 v[92:95], v[164:167], v[212:215], v[92:95]
v_fma_f32 v31, v31, v23, v23
v_add_f32 v23, s38, v23
v_mfma_f32_16x16x32_bf16 v[92:95], v[220:223], v[160:163], v[92:95]
v_rcp_f32 v31, v31
v_mfma_f32_16x16x32_bf16 v[92:95], v[136:139], v[200:203], v[92:95]
v_mul_f32 v31, v23, v31
v_cvt_pk_bf16_f32 v18, v28, v29
v_mfma_f32_16x16x32_bf16 v[76:79], v[136:139], v[176:179], v[76:79]
v_cvt_pk_bf16_f32 v19, v30, v31
v_fma_f32 v32, v32, s32, v246
v_mfma_f32_16x16x32_bf16 v[76:79], v[220:223], v[200:203], v[76:79]
v_permlane16_swap_b32 v16, v18
v_mfma_f32_16x16x32_bf16 v[76:79], v[164:167], v[160:163], v[76:79]
v_permlane16_swap_b32 v17, v19
v_mfma_f32_16x16x32_bf16 v[60:63], v[164:167], v[200:203], v[60:63]
buffer_store_dwordx4 v[16:19], v244, s[20:23], 0 offen offset:2048 sc0 sc1 nt
v_mfma_f32_16x16x32_bf16 v[60:63], v[220:223], v[176:179], v[60:63]
v_exp_f32 v32, v32
v_mfma_f32_16x16x32_bf16 v[60:63], v[136:139], v[128:131], v[60:63]
ds_read_b64_tr_b16 v[224:225], v243 offset:16384
v_fma_f32 v32, v32, s36, s36 clamp
v_mfma_f32_16x16x32_bf16 v[48:51], v[188:191], v[216:219], v[48:51]
ds_read_b64_tr_b16 v[226:227], v243 offset:17408
v_fma_f32 v40, v40, s34, v252
v_mfma_f32_16x16x32_bf16 v[48:51], v[196:199], v[132:135], v[48:51]
s_waitcnt lgkmcnt(14)
v_exp_f32 v40, v40
v_mfma_f32_16x16x32_bf16 v[48:51], v[228:231], v[156:159], v[48:51]
ds_read_b64_tr_b16 v[140:141], v243 offset:14336
v_fma_f32 v40, v40, v32, v32
v_mfma_f32_16x16x32_bf16 v[64:67], v[228:231], v[184:187], v[64:67]
v_rcp_f32 v40, v40
v_mfma_f32_16x16x32_bf16 v[64:67], v[196:199], v[156:159], v[64:67]
ds_read_b64_tr_b16 v[142:143], v243 offset:15360
v_add_f32 v32, s38, v32
v_mfma_f32_16x16x32_bf16 v[64:67], v[188:191], v[132:135], v[64:67]
ds_read_b64_tr_b16 v[180:181], v243 offset:12288
v_mul_f32 v40, v32, v40
v_mfma_f32_16x16x32_bf16 v[80:83], v[188:191], v[156:159], v[80:83]
ds_read_b64_tr_b16 v[182:183], v243 offset:13312
v_fma_f32 v33, v33, s32, v246
v_mfma_f32_16x16x32_bf16 v[80:83], v[196:199], v[184:187], v[80:83]
v_exp_f32 v33, v33
v_mfma_f32_16x16x32_bf16 v[80:83], v[228:231], v[152:155], v[80:83]
v_fma_f32 v33, v33, s36, s36 clamp
v_fma_f32 v41, v41, s34, v252
v_mfma_f32_16x16x32_bf16 v[96:99], v[228:231], v[208:211], v[96:99]
v_exp_f32 v41, v41
v_mfma_f32_16x16x32_bf16 v[96:99], v[196:199], v[152:155], v[96:99]
v_fma_f32 v41, v41, v33, v33
v_add_f32 v33, s38, v33
v_mfma_f32_16x16x32_bf16 v[96:99], v[188:191], v[184:187], v[96:99]
v_rcp_f32 v41, v41
v_mfma_f32_16x16x32_bf16 v[112:115], v[188:191], v[152:155], v[112:115]
ds_read_b64_tr_b16 v[204:205], v240 offset:18432
v_mul_f32 v41, v33, v41
v_mfma_f32_16x16x32_bf16 v[112:115], v[196:199], v[208:211], v[112:115]
ds_read_b64_tr_b16 v[206:207], v240 offset:19456
v_fma_f32 v34, v34, s32, v246
v_mfma_f32_16x16x32_bf16 v[112:115], v[228:231], v[172:175], v[112:115]
s_waitcnt lgkmcnt(14)
v_exp_f32 v34, v34
v_mfma_f32_16x16x32_bf16 v[120:123], v[192:195], v[172:175], v[120:123]
ds_read_b128 v[212:215], v238 offset:33536
v_fma_f32 v34, v34, s36, s36 clamp
v_mfma_f32_16x16x32_bf16 v[120:123], v[248:251], v[208:211], v[120:123]
ds_read_b64_tr_b16 v[160:161], v240 offset:20480
v_fma_f32 v42, v42, s34, v252
v_mfma_f32_16x16x32_bf16 v[120:123], v[232:235], v[152:155], v[120:123]
v_exp_f32 v42, v42
v_mfma_f32_16x16x32_bf16 v[104:107], v[232:235], v[184:187], v[104:107]
ds_read_b64_tr_b16 v[162:163], v240 offset:21504
v_fma_f32 v42, v42, v34, v34
v_mfma_f32_16x16x32_bf16 v[104:107], v[248:251], v[152:155], v[104:107]
v_rcp_f32 v42, v42
v_mfma_f32_16x16x32_bf16 v[104:107], v[192:195], v[208:211], v[104:107]
ds_read_b128 v[164:167], v238 offset:33792
v_add_f32 v34, s38, v34
v_mfma_f32_16x16x32_bf16 v[88:91], v[192:195], v[152:155], v[88:91]
ds_read_b64_tr_b16 v[200:201], v240 offset:22528
v_mul_f32 v42, v34, v42
v_mfma_f32_16x16x32_bf16 v[88:91], v[248:251], v[184:187], v[88:91]
ds_read_b64_tr_b16 v[202:203], v240 offset:23552
v_fma_f32 v35, v35, s32, v246
v_mfma_f32_16x16x32_bf16 v[88:91], v[232:235], v[156:159], v[88:91]
v_exp_f32 v35, v35
v_mfma_f32_16x16x32_bf16 v[72:75], v[232:235], v[132:135], v[72:75]
ds_read_b128 v[220:223], v238 offset:34048
v_fma_f32 v35, v35, s36, s36 clamp
v_mfma_f32_16x16x32_bf16 v[72:75], v[248:251], v[156:159], v[72:75]
ds_read_b64_tr_b16 v[176:177], v242 offset:22528
v_fma_f32 v43, v43, s34, v252
v_mfma_f32_16x16x32_bf16 v[72:75], v[192:195], v[184:187], v[72:75]
v_exp_f32 v43, v43
v_mfma_f32_16x16x32_bf16 v[56:59], v[192:195], v[156:159], v[56:59]
ds_read_b64_tr_b16 v[178:179], v242 offset:23552
v_fma_f32 v43, v43, v35, v35
v_mfma_f32_16x16x32_bf16 v[56:59], v[248:251], v[132:135], v[56:59]
v_rcp_f32 v43, v43
v_mfma_f32_16x16x32_bf16 v[56:59], v[232:235], v[216:219], v[56:59]
s_waitcnt lgkmcnt(14)
ds_read_b64_tr_b16 v[136:137], v242 offset:20480
v_add_f32 v35, s38, v35
v_mfma_f32_16x16x32_bf16 v[52:55], v[168:171], v[216:219], v[52:55]
ds_read_b64_tr_b16 v[138:139], v242 offset:21504
v_mul_f32 v43, v35, v43
v_mfma_f32_16x16x32_bf16 v[52:55], v[148:151], v[132:135], v[52:55]
ds_read_b64_tr_b16 v[128:129], v242 offset:18432
v_cvt_pk_bf16_f32 v32, v40, v41
v_mfma_f32_16x16x32_bf16 v[52:55], v[144:147], v[156:159], v[52:55]
ds_read_b64_tr_b16 v[130:131], v242 offset:19456
v_cvt_pk_bf16_f32 v33, v42, v43
v_mfma_f32_16x16x32_bf16 v[68:71], v[144:147], v[184:187], v[68:71]
ds_read_b64_tr_b16 v[188:189], v241 offset:18432
v_fma_f32 v36, v36, s32, v246
v_mfma_f32_16x16x32_bf16 v[68:71], v[148:151], v[156:159], v[68:71]
v_exp_f32 v36, v36
v_mfma_f32_16x16x32_bf16 v[68:71], v[168:171], v[132:135], v[68:71]
ds_read_b64_tr_b16 v[190:191], v241 offset:19456
v_fma_f32 v36, v36, s36, s36 clamp
v_mfma_f32_16x16x32_bf16 v[84:87], v[168:171], v[156:159], v[84:87]
ds_read_b64_tr_b16 v[196:197], v241 offset:20480
v_fma_f32 v44, v44, s34, v252
v_mfma_f32_16x16x32_bf16 v[84:87], v[148:151], v[184:187], v[84:87]
v_exp_f32 v44, v44
v_mfma_f32_16x16x32_bf16 v[84:87], v[144:147], v[152:155], v[84:87]
ds_read_b64_tr_b16 v[198:199], v241 offset:21504
v_fma_f32 v44, v44, v36, v36
v_mfma_f32_16x16x32_bf16 v[100:103], v[144:147], v[208:211], v[100:103]
v_rcp_f32 v44, v44
v_mfma_f32_16x16x32_bf16 v[100:103], v[148:151], v[152:155], v[100:103]
ds_read_b64_tr_b16 v[228:229], v241 offset:22528
v_add_f32 v36, s38, v36
v_mfma_f32_16x16x32_bf16 v[100:103], v[168:171], v[184:187], v[100:103]
ds_read_b64_tr_b16 v[230:231], v241 offset:23552
v_mul_f32 v44, v36, v44
v_mfma_f32_16x16x32_bf16 v[116:119], v[168:171], v[152:155], v[116:119]
ds_read_b64_tr_b16 v[192:193], v243 offset:22528
v_fma_f32 v37, v37, s32, v246
v_mfma_f32_16x16x32_bf16 v[116:119], v[148:151], v[208:211], v[116:119]
v_exp_f32 v37, v37
v_mfma_f32_16x16x32_bf16 v[116:119], v[144:147], v[172:175], v[116:119]
ds_read_b64_tr_b16 v[194:195], v243 offset:23552
v_fma_f32 v37, v37, s36, s36 clamp
v_mfma_f32_16x16x32_bf16 v[124:127], v[224:227], v[172:175], v[124:127]
s_waitcnt lgkmcnt(14)
ds_read_b64_tr_b16 v[248:249], v243 offset:20480
v_fma_f32 v45, v45, s34, v252
v_mfma_f32_16x16x32_bf16 v[124:127], v[140:143], v[208:211], v[124:127]
v_exp_f32 v45, v45
v_mfma_f32_16x16x32_bf16 v[124:127], v[180:183], v[152:155], v[124:127]
ds_read_b64_tr_b16 v[250:251], v243 offset:21504
v_fma_f32 v45, v45, v37, v37
v_mfma_f32_16x16x32_bf16 v[108:111], v[180:183], v[184:187], v[108:111]
v_rcp_f32 v45, v45
v_mfma_f32_16x16x32_bf16 v[108:111], v[140:143], v[152:155], v[108:111]
ds_read_b64_tr_b16 v[232:233], v243 offset:18432
v_add_f32 v37, s38, v37
v_mfma_f32_16x16x32_bf16 v[108:111], v[224:227], v[208:211], v[108:111]
ds_read_b64_tr_b16 v[234:235], v243 offset:19456
v_mul_f32 v45, v37, v45
v_mfma_f32_16x16x32_bf16 v[92:95], v[224:227], v[152:155], v[92:95]
ds_read_b128 v[168:171], v238 offset:34304
v_fma_f32 v38, v38, s32, v246
v_mfma_f32_16x16x32_bf16 v[92:95], v[140:143], v[184:187], v[92:95]
v_exp_f32 v38, v38
v_mfma_f32_16x16x32_bf16 v[92:95], v[180:183], v[156:159], v[92:95]
ds_read_b128 v[148:151], v238 offset:34560
v_fma_f32 v38, v38, s36, s36 clamp
v_mfma_f32_16x16x32_bf16 v[76:79], v[180:183], v[132:135], v[76:79]
ds_read_b128 v[144:147], v239 offset:32768
v_fma_f32 v46, v46, s34, v252
v_mfma_f32_16x16x32_bf16 v[76:79], v[140:143], v[156:159], v[76:79]
v_exp_f32 v46, v46
v_mfma_f32_16x16x32_bf16 v[76:79], v[224:227], v[184:187], v[76:79]
v_fma_f32 v46, v46, v38, v38
v_add_f32 v38, s38, v38
v_mfma_f32_16x16x32_bf16 v[60:63], v[224:227], v[156:159], v[60:63]
v_rcp_f32 v46, v46
v_mfma_f32_16x16x32_bf16 v[60:63], v[140:143], v[132:135], v[60:63]
v_mul_f32 v46, v38, v46
v_fma_f32 v39, v39, s32, v246
v_mfma_f32_16x16x32_bf16 v[60:63], v[180:183], v[216:219], v[60:63]
v_exp_f32 v39, v39
v_mfma_f32_16x16x32_bf16 v[48:51], v[204:207], v[212:215], v[48:51]
v_fma_f32 v39, v39, s36, s36 clamp
v_fma_f32 v47, v47, s34, v252
v_mfma_f32_16x16x32_bf16 v[48:51], v[160:163], v[164:167], v[48:51]
v_exp_f32 v47, v47
v_mfma_f32_16x16x32_bf16 v[48:51], v[200:203], v[220:223], v[48:51]
s_waitcnt lgkmcnt(14)
ds_read_b128 v[172:175], v239 offset:33024
v_fma_f32 v47, v47, v39, v39
v_mfma_f32_16x16x32_bf16 v[56:59], v[176:179], v[220:223], v[56:59]
v_rcp_f32 v47, v47
v_mfma_f32_16x16x32_bf16 v[56:59], v[136:139], v[164:167], v[56:59]
v_add_f32 v39, s38, v39
v_mul_f32 v47, v39, v47
v_mfma_f32_16x16x32_bf16 v[56:59], v[128:131], v[212:215], v[56:59]
s_waitcnt lgkmcnt(14)
v_cvt_pk_bf16_f32 v34, v44, v45
v_cvt_pk_bf16_f32 v35, v46, v47
v_mfma_f32_16x16x32_bf16 v[52:55], v[188:191], v[212:215], v[52:55]
s_waitcnt lgkmcnt(12)
v_permlane16_swap_b32 v32, v34
v_mfma_f32_16x16x32_bf16 v[52:55], v[196:199], v[164:167], v[52:55]
s_waitcnt lgkmcnt(10)
v_permlane16_swap_b32 v33, v35
v_mfma_f32_16x16x32_bf16 v[52:55], v[228:231], v[220:223], v[52:55]
s_waitcnt lgkmcnt(8)
buffer_store_dwordx4 v[32:35], v244, s[20:23], s93 offen offset:0 sc0 sc1 nt
v_mfma_f32_16x16x32_bf16 v[60:63], v[192:195], v[220:223], v[60:63]
s_waitcnt lgkmcnt(6)
v_fma_f32 v48, v48, s32, v246
v_fma_f32 v56, v56, s34, v252
v_mfma_f32_16x16x32_bf16 v[60:63], v[248:251], v[164:167], v[60:63]
s_waitcnt lgkmcnt(4)
v_exp_f32 v48, v48
v_mfma_f32_16x16x32_bf16 v[60:63], v[232:235], v[212:215], v[60:63]
v_exp_f32 v56, v56
v_mfma_f32_16x16x32_bf16 v[64:67], v[204:207], v[164:167], v[64:67]
v_fma_f32 v48, v48, s36, s36 clamp
v_fma_f32 v56, v56, v48, v48
v_mfma_f32_16x16x32_bf16 v[64:67], v[160:163], v[220:223], v[64:67]
s_waitcnt lgkmcnt(3)
v_rcp_f32 v56, v56
v_mfma_f32_16x16x32_bf16 v[64:67], v[200:203], v[168:171], v[64:67]
v_add_f32 v48, s38, v48
v_mul_f32 v56, v48, v56
v_mfma_f32_16x16x32_bf16 v[72:75], v[176:179], v[168:171], v[72:75]
v_fma_f32 v49, v49, s32, v246
v_fma_f32 v57, v57, s34, v252
v_mfma_f32_16x16x32_bf16 v[72:75], v[136:139], v[220:223], v[72:75]
v_exp_f32 v49, v49
v_mfma_f32_16x16x32_bf16 v[72:75], v[128:131], v[164:167], v[72:75]
v_exp_f32 v57, v57
v_mfma_f32_16x16x32_bf16 v[68:71], v[188:191], v[164:167], v[68:71]
v_fma_f32 v49, v49, s36, s36 clamp
v_fma_f32 v57, v57, v49, v49
v_mfma_f32_16x16x32_bf16 v[68:71], v[196:199], v[220:223], v[68:71]
v_rcp_f32 v57, v57
v_mfma_f32_16x16x32_bf16 v[68:71], v[228:231], v[168:171], v[68:71]
v_add_f32 v49, s38, v49
v_mul_f32 v57, v49, v57
v_mfma_f32_16x16x32_bf16 v[76:79], v[192:195], v[168:171], v[76:79]
v_fma_f32 v50, v50, s32, v246
v_fma_f32 v58, v58, s34, v252
v_mfma_f32_16x16x32_bf16 v[76:79], v[248:251], v[220:223], v[76:79]
v_exp_f32 v50, v50
v_mfma_f32_16x16x32_bf16 v[76:79], v[232:235], v[164:167], v[76:79]
v_exp_f32 v58, v58
v_mfma_f32_16x16x32_bf16 v[80:83], v[204:207], v[220:223], v[80:83]
v_fma_f32 v50, v50, s36, s36 clamp
v_fma_f32 v58, v58, v50, v50
v_mfma_f32_16x16x32_bf16 v[80:83], v[160:163], v[168:171], v[80:83]
s_waitcnt lgkmcnt(2)
v_rcp_f32 v58, v58
v_mfma_f32_16x16x32_bf16 v[80:83], v[200:203], v[148:151], v[80:83]
v_add_f32 v50, s38, v50
v_mul_f32 v58, v50, v58
v_mfma_f32_16x16x32_bf16 v[88:91], v[176:179], v[148:151], v[88:91]
v_fma_f32 v51, v51, s32, v246
v_fma_f32 v59, v59, s34, v252
v_mfma_f32_16x16x32_bf16 v[88:91], v[136:139], v[168:171], v[88:91]
v_exp_f32 v51, v51
v_mfma_f32_16x16x32_bf16 v[88:91], v[128:131], v[220:223], v[88:91]
v_exp_f32 v59, v59
v_mfma_f32_16x16x32_bf16 v[84:87], v[188:191], v[220:223], v[84:87]
L_pad5:
s_cmp_eq_u32 s79, 1
s_cbranch_scc1 L_lret5
v_fma_f32 v51, v51, s36, s36 clamp
v_fma_f32 v59, v59, v51, v51
v_mfma_f32_16x16x32_bf16 v[84:87], v[196:199], v[168:171], v[84:87]
v_rcp_f32 v59, v59
v_mfma_f32_16x16x32_bf16 v[84:87], v[228:231], v[148:151], v[84:87]
v_add_f32 v51, s38, v51
v_mul_f32 v59, v51, v59
v_mfma_f32_16x16x32_bf16 v[92:95], v[192:195], v[148:151], v[92:95]
v_cvt_pk_bf16_f32 v48, v56, v57
v_cvt_pk_bf16_f32 v49, v58, v59
v_mfma_f32_16x16x32_bf16 v[92:95], v[248:251], v[168:171], v[92:95]
v_fma_f32 v52, v52, s32, v246
v_fma_f32 v60, v60, s34, v252
v_mfma_f32_16x16x32_bf16 v[92:95], v[232:235], v[220:223], v[92:95]
v_exp_f32 v52, v52
v_mfma_f32_16x16x32_bf16 v[96:99], v[204:207], v[168:171], v[96:99]
v_exp_f32 v60, v60
v_mfma_f32_16x16x32_bf16 v[96:99], v[160:163], v[148:151], v[96:99]
s_waitcnt lgkmcnt(1)
v_fma_f32 v52, v52, s36, s36 clamp
v_fma_f32 v60, v60, v52, v52
v_mfma_f32_16x16x32_bf16 v[96:99], v[200:203], v[144:147], v[96:99]
v_rcp_f32 v60, v60
v_mfma_f32_16x16x32_bf16 v[104:107], v[176:179], v[144:147], v[104:107]
v_add_f32 v52, s38, v52
v_mul_f32 v60, v52, v60
v_mfma_f32_16x16x32_bf16 v[104:107], v[136:139], v[148:151], v[104:107]
v_fma_f32 v53, v53, s32, v246
v_fma_f32 v61, v61, s34, v252
v_mfma_f32_16x16x32_bf16 v[104:107], v[128:131], v[168:171], v[104:107]
v_exp_f32 v53, v53
v_mfma_f32_16x16x32_bf16 v[100:103], v[188:191], v[168:171], v[100:103]
v_exp_f32 v61, v61
v_mfma_f32_16x16x32_bf16 v[100:103], v[196:199], v[148:151], v[100:103]
v_fma_f32 v53, v53, s36, s36 clamp
v_fma_f32 v61, v61, v53, v53
v_mfma_f32_16x16x32_bf16 v[100:103], v[228:231], v[144:147], v[100:103]
v_rcp_f32 v61, v61
v_mfma_f32_16x16x32_bf16 v[108:111], v[192:195], v[144:147], v[108:111]
v_add_f32 v53, s38, v53
v_mul_f32 v61, v53, v61
v_mfma_f32_16x16x32_bf16 v[108:111], v[248:251], v[148:151], v[108:111]
v_fma_f32 v54, v54, s32, v246
v_fma_f32 v62, v62, s34, v252
v_mfma_f32_16x16x32_bf16 v[108:111], v[232:235], v[168:171], v[108:111]
v_exp_f32 v54, v54
v_mfma_f32_16x16x32_bf16 v[112:115], v[204:207], v[148:151], v[112:115]
v_exp_f32 v62, v62
v_mfma_f32_16x16x32_bf16 v[112:115], v[160:163], v[144:147], v[112:115]
s_waitcnt lgkmcnt(0)
v_fma_f32 v54, v54, s36, s36 clamp
v_fma_f32 v62, v62, v54, v54
v_mfma_f32_16x16x32_bf16 v[112:115], v[200:203], v[172:175], v[112:115]
v_rcp_f32 v62, v62
v_mfma_f32_16x16x32_bf16 v[120:123], v[176:179], v[172:175], v[120:123]
v_add_f32 v54, s38, v54
v_mul_f32 v62, v54, v62
v_mfma_f32_16x16x32_bf16 v[120:123], v[136:139], v[144:147], v[120:123]
v_fma_f32 v55, v55, s32, v246
v_fma_f32 v63, v63, s34, v252
v_mfma_f32_16x16x32_bf16 v[120:123], v[128:131], v[148:151], v[120:123]
v_exp_f32 v55, v55
v_mfma_f32_16x16x32_bf16 v[116:119], v[188:191], v[148:151], v[116:119]
v_exp_f32 v63, v63
v_mfma_f32_16x16x32_bf16 v[116:119], v[196:199], v[144:147], v[116:119]
v_fma_f32 v55, v55, s36, s36 clamp
v_fma_f32 v63, v63, v55, v55
v_mfma_f32_16x16x32_bf16 v[116:119], v[228:231], v[172:175], v[116:119]
v_rcp_f32 v63, v63
v_mfma_f32_16x16x32_bf16 v[124:127], v[192:195], v[172:175], v[124:127]
v_add_f32 v55, s38, v55
v_mul_f32 v63, v55, v63
v_mfma_f32_16x16x32_bf16 v[124:127], v[248:251], v[144:147], v[124:127]
v_cvt_pk_bf16_f32 v50, v60, v61
v_cvt_pk_bf16_f32 v51, v62, v63
v_mfma_f32_16x16x32_bf16 v[124:127], v[232:235], v[148:151], v[124:127]
v_pk_fma_f32 v[64:65], v[64:65], s[32:33], v[246:247]
v_permlane16_swap_b32 v48, v50
v_pk_fma_f32 v[72:73], v[72:73], s[34:35], v[252:253]
v_permlane16_swap_b32 v49, v51
v_pk_fma_f32 v[66:67], v[66:67], s[32:33], v[246:247]
buffer_store_dwordx4 v[48:51], v244, s[20:23], s93 offen offset:2048 sc0 sc1 nt
v_exp_f32 v64, v64
v_pk_fma_f32 v[74:75], v[74:75], s[34:35], v[252:253]
v_exp_f32 v65, v65
v_pk_fma_f32 v[68:69], v[68:69], s[32:33], v[246:247]
v_exp_f32 v72, v72
v_pk_fma_f32 v[64:65], v[64:65], s[36:37], s[36:37] clamp
v_exp_f32 v73, v73
v_pk_fma_f32 v[76:77], v[76:77], s[34:35], v[252:253]
v_exp_f32 v66, v66
v_pk_fma_f32 v[72:73], v[72:73], v[64:65], v[64:65]
v_rcp_f32 v72, v72
v_pk_add_f32 v[64:65], v[64:65], s[38:39]
v_rcp_f32 v73, v73
v_pk_fma_f32 v[70:71], v[70:71], s[32:33], v[246:247]
v_exp_f32 v67, v67
v_pk_mul_f32 v[72:73], v[64:65], v[72:73]
v_exp_f32 v74, v74
v_pk_fma_f32 v[66:67], v[66:67], s[36:37], s[36:37] clamp
v_exp_f32 v75, v75
v_pk_fma_f32 v[78:79], v[78:79], s[34:35], v[252:253]
v_exp_f32 v68, v68
v_pk_fma_f32 v[74:75], v[74:75], v[66:67], v[66:67]
v_rcp_f32 v74, v74
v_pk_add_f32 v[66:67], v[66:67], s[38:39]
v_rcp_f32 v75, v75
v_pk_fma_f32 v[80:81], v[80:81], s[32:33], v[246:247]
v_exp_f32 v69, v69
v_pk_mul_f32 v[74:75], v[66:67], v[74:75]
v_exp_f32 v76, v76
v_cvt_pk_bf16_f32 v64, v72, v73
v_exp_f32 v77, v77
v_cvt_pk_bf16_f32 v65, v74, v75
v_exp_f32 v70, v70
v_pk_fma_f32 v[68:69], v[68:69], s[36:37], s[36:37] clamp
v_exp_f32 v71, v71
v_pk_fma_f32 v[76:77], v[76:77], v[68:69], v[68:69]
v_rcp_f32 v76, v76
v_pk_add_f32 v[68:69], v[68:69], s[38:39]
v_rcp_f32 v77, v77
v_pk_fma_f32 v[70:71], v[70:71], s[36:37], s[36:37] clamp
v_exp_f32 v78, v78
v_pk_mul_f32 v[76:77], v[68:69], v[76:77]
v_exp_f32 v79, v79
v_pk_fma_f32 v[88:89], v[88:89], s[34:35], v[252:253]
v_exp_f32 v80, v80
v_pk_fma_f32 v[78:79], v[78:79], v[70:71], v[70:71]
v_rcp_f32 v78, v78
v_pk_add_f32 v[70:71], v[70:71], s[38:39]
v_rcp_f32 v79, v79
v_pk_fma_f32 v[82:83], v[82:83], s[32:33], v[246:247]
v_exp_f32 v81, v81
v_pk_mul_f32 v[78:79], v[70:71], v[78:79]
v_exp_f32 v88, v88
v_cvt_pk_bf16_f32 v66, v76, v77
v_exp_f32 v89, v89
v_cvt_pk_bf16_f32 v67, v78, v79
v_exp_f32 v82, v82
v_pk_fma_f32 v[80:81], v[80:81], s[36:37], s[36:37] clamp
v_permlane16_swap_b32 v64, v66
v_pk_fma_f32 v[88:89], v[88:89], v[80:81], v[80:81]
v_permlane16_swap_b32 v65, v67
v_pk_add_f32 v[80:81], v[80:81], s[38:39]
buffer_store_dwordx4 v[64:67], v244, s[20:23], s94 offen offset:0 sc0 sc1 nt
v_rcp_f32 v88, v88
v_pk_fma_f32 v[90:91], v[90:91], s[34:35], v[252:253]
v_rcp_f32 v89, v89
v_pk_fma_f32 v[84:85], v[84:85], s[32:33], v[246:247]
v_exp_f32 v83, v83
v_pk_mul_f32 v[88:89], v[80:81], v[88:89]
v_exp_f32 v90, v90
v_pk_fma_f32 v[82:83], v[82:83], s[36:37], s[36:37] clamp
v_exp_f32 v91, v91
v_pk_fma_f32 v[92:93], v[92:93], s[34:35], v[252:253]
v_exp_f32 v84, v84
v_pk_fma_f32 v[90:91], v[90:91], v[82:83], v[82:83]
v_rcp_f32 v90, v90
v_pk_add_f32 v[82:83], v[82:83], s[38:39]
v_rcp_f32 v91, v91
v_pk_fma_f32 v[86:87], v[86:87], s[32:33], v[246:247]
v_exp_f32 v85, v85
v_pk_mul_f32 v[90:91], v[82:83], v[90:91]
v_exp_f32 v92, v92
v_cvt_pk_bf16_f32 v80, v88, v89
v_exp_f32 v93, v93
v_cvt_pk_bf16_f32 v81, v90, v91
v_exp_f32 v86, v86
v_pk_fma_f32 v[84:85], v[84:85], s[36:37], s[36:37] clamp
v_exp_f32 v87, v87
v_pk_fma_f32 v[92:93], v[92:93], v[84:85], v[84:85]
v_rcp_f32 v92, v92
v_pk_add_f32 v[84:85], v[84:85], s[38:39]
v_rcp_f32 v93, v93
v_pk_fma_f32 v[86:87], v[86:87], s[36:37], s[36:37] clamp
v_pk_mul_f32 v[92:93], v[84:85], v[92:93]
v_pk_fma_f32 v[94:95], v[94:95], s[34:35], v[252:253]
v_exp_f32 v94, v94
v_pk_fma_f32 v[96:97], v[96:97], s[32:33], v[246:247]
v_exp_f32 v95, v95
v_pk_fma_f32 v[104:105], v[104:105], s[34:35], v[252:253]
v_exp_f32 v96, v96
v_pk_fma_f32 v[94:95], v[94:95], v[86:87], v[86:87]
v_rcp_f32 v94, v94
v_pk_add_f32 v[86:87], v[86:87], s[38:39]
v_rcp_f32 v95, v95
v_pk_fma_f32 v[98:99], v[98:99], s[32:33], v[246:247]
v_exp_f32 v97, v97
v_pk_mul_f32 v[94:95], v[86:87], v[94:95]
v_exp_f32 v104, v104
v_cvt_pk_bf16_f32 v82, v92, v93
v_exp_f32 v105, v105
v_cvt_pk_bf16_f32 v83, v94, v95
v_exp_f32 v98, v98
v_pk_fma_f32 v[96:97], v[96:97], s[36:37], s[36:37] clamp
v_permlane16_swap_b32 v80, v82
v_pk_fma_f32 v[104:105], v[104:105], v[96:97], v[96:97]
v_permlane16_swap_b32 v81, v83
v_pk_add_f32 v[96:97], v[96:97], s[38:39]
buffer_store_dwordx4 v[80:83], v245, s[20:23], s94 offen offset:2048 sc0 sc1 nt
v_rcp_f32 v104, v104
v_pk_fma_f32 v[106:107], v[106:107], s[34:35], v[252:253]
v_rcp_f32 v105, v105
v_pk_fma_f32 v[100:101], v[100:101], s[32:33], v[246:247]
v_exp_f32 v99, v99
v_pk_mul_f32 v[104:105], v[96:97], v[104:105]
v_exp_f32 v106, v106
v_pk_fma_f32 v[98:99], v[98:99], s[36:37], s[36:37] clamp
v_exp_f32 v107, v107
v_pk_fma_f32 v[108:109], v[108:109], s[34:35], v[252:253]
v_exp_f32 v100, v100
v_pk_fma_f32 v[106:107], v[106:107], v[98:99], v[98:99]
v_rcp_f32 v106, v106
v_pk_add_f32 v[98:99], v[98:99], s[38:39]
v_rcp_f32 v107, v107
v_pk_fma_f32 v[102:103], v[102:103], s[32:33], v[246:247]
v_exp_f32 v101, v101
v_pk_mul_f32 v[106:107], v[98:99], v[106:107]
v_exp_f32 v108, v108
v_cvt_pk_bf16_f32 v96, v104, v105
v_exp_f32 v109, v109
v_cvt_pk_bf16_f32 v97, v106, v107
v_exp_f32 v102, v102
v_pk_fma_f32 v[100:101], v[100:101], s[36:37], s[36:37] clamp
v_exp_f32 v103, v103
v_pk_fma_f32 v[108:109], v[108:109], v[100:101], v[100:101]
v_rcp_f32 v108, v108
v_pk_add_f32 v[100:101], v[100:101], s[38:39]
v_rcp_f32 v109, v109
v_pk_fma_f32 v[102:103], v[102:103], s[36:37], s[36:37] clamp
v_pk_mul_f32 v[108:109], v[100:101], v[108:109]
v_pk_fma_f32 v[110:111], v[110:111], s[34:35], v[252:253]
v_exp_f32 v110, v110
v_pk_fma_f32 v[112:113], v[112:113], s[32:33], v[246:247]
v_exp_f32 v111, v111
v_pk_fma_f32 v[120:121], v[120:121], s[34:35], v[252:253]
v_exp_f32 v112, v112
v_pk_fma_f32 v[110:111], v[110:111], v[102:103], v[102:103]
v_rcp_f32 v110, v110
v_pk_add_f32 v[102:103], v[102:103], s[38:39]
v_rcp_f32 v111, v111
v_pk_fma_f32 v[114:115], v[114:115], s[32:33], v[246:247]
v_exp_f32 v113, v113
v_pk_mul_f32 v[110:111], v[102:103], v[110:111]
v_exp_f32 v120, v120
v_cvt_pk_bf16_f32 v98, v108, v109
v_exp_f32 v121, v121
v_cvt_pk_bf16_f32 v99, v110, v111
v_exp_f32 v114, v114
v_pk_fma_f32 v[112:113], v[112:113], s[36:37], s[36:37] clamp
v_permlane16_swap_b32 v96, v98
v_pk_fma_f32 v[120:121], v[120:121], v[112:113], v[112:113]
v_permlane16_swap_b32 v97, v99
v_pk_add_f32 v[112:113], v[112:113], s[38:39]
buffer_store_dwordx4 v[96:99], v245, s[20:23], s95 offen offset:0 sc0 sc1 nt
v_rcp_f32 v120, v120
v_pk_fma_f32 v[122:123], v[122:123], s[34:35], v[252:253]
v_rcp_f32 v121, v121
v_pk_fma_f32 v[116:117], v[116:117], s[32:33], v[246:247]
v_exp_f32 v115, v115
v_pk_mul_f32 v[120:121], v[112:113], v[120:121]
v_exp_f32 v122, v122
v_pk_fma_f32 v[114:115], v[114:115], s[36:37], s[36:37] clamp
v_exp_f32 v123, v123
v_pk_fma_f32 v[124:125], v[124:125], s[34:35], v[252:253]
v_exp_f32 v116, v116
v_pk_fma_f32 v[122:123], v[122:123], v[114:115], v[114:115]
v_rcp_f32 v122, v122
v_pk_add_f32 v[114:115], v[114:115], s[38:39]
v_rcp_f32 v123, v123
v_pk_fma_f32 v[118:119], v[118:119], s[32:33], v[246:247]
v_exp_f32 v117, v117
v_pk_mul_f32 v[122:123], v[114:115], v[122:123]
v_exp_f32 v124, v124
v_cvt_pk_bf16_f32 v112, v120, v121
v_exp_f32 v125, v125
v_cvt_pk_bf16_f32 v113, v122, v123
v_exp_f32 v118, v118
v_pk_fma_f32 v[116:117], v[116:117], s[36:37], s[36:37] clamp
v_exp_f32 v119, v119
v_pk_fma_f32 v[124:125], v[124:125], v[116:117], v[116:117]
v_rcp_f32 v124, v124
v_pk_add_f32 v[116:117], v[116:117], s[38:39]
v_rcp_f32 v125, v125
v_pk_fma_f32 v[118:119], v[118:119], s[36:37], s[36:37] clamp
v_pk_mul_f32 v[124:125], v[116:117], v[124:125]
v_pk_fma_f32 v[126:127], v[126:127], s[34:35], v[252:253]
v_exp_f32 v126, v126
v_exp_f32 v127, v127
s_nop 0
v_pk_fma_f32 v[126:127], v[126:127], v[118:119], v[118:119]
v_rcp_f32 v126, v126
v_pk_add_f32 v[118:119], v[118:119], s[38:39]
v_rcp_f32 v127, v127
s_nop 0
v_pk_mul_f32 v[126:127], v[118:119], v[126:127]
v_cvt_pk_bf16_f32 v114, v124, v125
v_cvt_pk_bf16_f32 v115, v126, v127
s_nop 0
s_nop 0
v_permlane16_swap_b32 v112, v114
v_permlane16_swap_b32 v113, v115
s_nop 0
buffer_store_dwordx4 v[112:115], v245, s[20:23], s95 offen offset:2048 sc0 sc1 nt
s_endpgm
L_end:
.section .rodata,"a"
.p2align 6
.amdhsa_kernel standalone__autoregressive_conv_wavernn__speech_kernel
  .amdhsa_next_free_vgpr 256
  .amdhsa_next_free_sgpr 102
  .amdhsa_accum_offset 256
  .amdhsa_group_segment_fixed_size 0
  .amdhsa_kernarg_size 40
  .amdhsa_user_sgpr_count 2
  .amdhsa_user_sgpr_kernarg_segment_ptr 1
  .amdhsa_system_sgpr_workgroup_id_x 1
  .amdhsa_dx10_clamp 0
.end_amdhsa_kernel
```
